```python
import torch

def _softmax(x, axis=-1):
    return torch.softmax(x, dim=axis)
def _gelu(x):
    return torch.nn.functional.gelu(x, approximate="tanh")
def _silu(x):
    return torch.nn.functional.silu(x)
def _sigmoid(x):
    return torch.sigmoid(x)
def _layernorm(x, axis=-1, eps=1e-5):
    m = x.mean(dim=axis, keepdim=True)
    v = x.var(dim=axis, keepdim=True, unbiased=False)
    return (x - m) / torch.sqrt(v + eps)
def _scatter_add(tgt, idx, src, axis=0):
    return tgt.clone().index_add_(axis, idx, src)
def _segment_sum(src, seg, n):
    out = torch.zeros((n,) + src.shape[1:], dtype=src.dtype)
    return out.index_add_(0, seg, src)
def _pad(x, pw):
    flat = tuple(v for pair in reversed(pw) for v in pair)
    return torch.nn.functional.pad(x, flat)

kernel_name = 'parallel_sum__softmax_full_mha__glu_gated_swiglu__prompt'

def setup_inputs():

    _w = (lambda a: (lambda t: t.to(torch.bfloat16) if t.is_floating_point() else t)(torch.as_tensor(a)))
    def _A_setup():
        B, S, D = 1, 2048, 448
        return {
            "x": _w((lambda *s: torch.randn(*s, dtype=torch.bfloat16) * 0.05)(B, S, D)),
            "wqkv": _w((lambda *s: torch.randn(*s, dtype=torch.bfloat16) * 0.05)(D, 3 * D)),
            "wo": _w((lambda *s: torch.randn(*s, dtype=torch.bfloat16) * 0.05)(D, D)),
        }
    _A_in = _A_setup()

    def _B_setup():
        B, S, D, F = 1, 2048, 448, 1792
        return {
            "x": _w((lambda *s: torch.randn(*s, dtype=torch.bfloat16) * 0.05)(B, S, D)),
            "w1": _w((lambda *s: torch.randn(*s, dtype=torch.bfloat16) * 0.4)(D, F) * (2.0 / D) ** 0.5),
            "w3": _w((lambda *s: torch.randn(*s, dtype=torch.bfloat16) * 0.4)(D, F) * (2.0 / D) ** 0.5),
            "w2": _w((lambda *s: torch.randn(*s, dtype=torch.bfloat16) * 0.4)(F, D) * (2.0 / F) ** 0.5),
        }
    _B_in = _B_setup()

    return {
        "A_x": _A_in["x"],
        "A_wqkv": _A_in["wqkv"],
        "A_wo": _A_in["wo"],
        "B_x": _B_in["x"],
        "B_w1": _B_in["w1"],
        "B_w3": _B_in["w3"],
        "B_w2": _B_in["w2"],
    }

def reference(A_x, A_wqkv, A_wo, B_x, B_w1, B_w3, B_w2):
    def _A_ref(x, wqkv, wo):
        B, S, D = x.shape
        H = 16; Dh = D // H
        qkv = (lambda x, *d: x.permute(*d))((x @ wqkv).reshape(B, S, 3, H, Dh), 2, 0, 3, 1, 4)
        q, k, v = qkv[0], qkv[1], qkv[2]
        scale = Dh ** -0.5
        scores = torch.einsum("bhqd,bhkd->bhqk", q, k) * scale
        p = _softmax(scores, axis=-1)
        o = torch.einsum("bhqk,bhkd->bhqd", p, v)
        return (lambda x, *d: x.permute(*d))(o, 0, 2, 1, 3).reshape(B, S, D) @ wo

    def _B_ref(x, w1, w3, w2):
        gate = torch.einsum("bsd,df->bsf", x, w1)
        up = torch.einsum("bsd,df->bsf", x, w3)
        h = _silu(gate) * up
        out = torch.einsum("bsf,fd->bsd", h, w2)
        return out

    x = A_x
    xn = _layernorm(x, axis=-1)
    return x + _A_ref(xn, A_wqkv, A_wo) + _B_ref(xn, B_w1, B_w3, B_w2)
```

```asm
; @launch grid=(256,1,1) block=(512,1,1) lds=163840
.amdgcn_target "amdgcn-amd-amdhsa--gfx950"
.text
.globl parallel_sum__softmax_full_mha__glu_gated_swiglu__prompt_kernel
.p2align 8
.type parallel_sum__softmax_full_mha__glu_gated_swiglu__prompt_kernel,@function
parallel_sum__softmax_full_mha__glu_gated_swiglu__prompt_kernel:
    s_cmp_ge_u32 s2, 256
    s_cbranch_scc1 L_parallel_sum__softmax_full_mha__glu_gated_swiglu__prompt_kernel_end
    s_load_dwordx16 s[40:55], s[0:1], 0
    s_load_dwordx4 s[56:59], s[0:1], 64
    s_getpc_b64 s[96:97]
L_parallel_sum__softmax_full_mha__glu_gated_swiglu__prompt_kernel_pc:
    s_sub_u32 s96, s96, L_parallel_sum__softmax_full_mha__glu_gated_swiglu__prompt_kernel_pc-parallel_sum__softmax_full_mha__glu_gated_swiglu__prompt_kernel
    s_subb_u32 s97, s97, 0
    v_lshrrev_b32 v1, 6, v0
    v_cmp_eq_u32 vcc, 7, v1
    s_nop 0
    s_and_saveexec_b64 s[94:95], vcc
    s_cbranch_execz L_parallel_sum__softmax_full_mha__glu_gated_swiglu__prompt_kernel_nopf
    s_lshr_b32 s3, s2, 3
    s_and_b32 s3, s3, 7
    s_lshl_b32 s3, s3, 13
    v_and_b32 v1, 63, v0
    v_lshlrev_b32 v1, 7, v1
    v_add_u32 v1, s3, v1
    v_min_u32 v1, L_parallel_sum__softmax_full_mha__glu_gated_swiglu__prompt_kernel_last-parallel_sum__softmax_full_mha__glu_gated_swiglu__prompt_kernel, v1
    global_load_dword v254, v1, s[96:97]
L_parallel_sum__softmax_full_mha__glu_gated_swiglu__prompt_kernel_nopf:
    s_mov_b64 exec, -1
    s_and_b32 s27, s2, 7
    s_lshr_b32 s28, s2, 3
    s_lshr_b32 s37, s27, 1
    s_lshl_b32 s37, s37, 2
    s_and_b32 s38, s28, 3
    s_add_u32 s29, s37, s38
    s_and_b32 s37, s27, 1
    s_mul_i32 s37, s37, 7
    s_lshr_b32 s39, s28, 2
    s_add_u32 s30, s37, s39
    s_lshl_b32 s38, s38, 1
    s_add_u32 s38, s38, s39
    s_cmp_ge_u32 s38, 7
    s_cselect_b32 s39, 7, 0
    s_sub_u32 s31, s38, s39
    v_lshrrev_b32 v1, 6, v0
    v_and_b32 v0, 63, v0
    s_nop 0
    v_readfirstlane_b32 s26, v1
    s_nop 3
    s_and_b32 s32, s26, 3
    s_lshr_b32 s33, s26, 2
    s_lshl_b32 s35, s29, 2
    s_add_u32 s35, s35, s32
    s_lshl_b32 s60, s31, 7
    s_add_u32 s61, s60, 128
    s_cmp_eq_u32 s61, 896
    s_cselect_b32 s61, 0, s61
    s_add_u32 s62, s61, 128
    s_cmp_eq_u32 s62, 896
    s_cselect_b32 s62, 0, s62
    s_add_u32 s63, s62, 128
    s_cmp_eq_u32 s63, 896
    s_cselect_b32 s63, 0, s63
    s_add_u32 s64, s63, 128
    s_cmp_eq_u32 s64, 896
    s_cselect_b32 s64, 0, s64
    s_add_u32 s65, s64, 128
    s_cmp_eq_u32 s65, 896
    s_cselect_b32 s65, 0, s65
    s_add_u32 s66, s65, 128
    s_cmp_eq_u32 s66, 896
    s_cselect_b32 s66, 0, s66
    s_waitcnt lgkmcnt(0)
    s_mov_b32 s8, s40
    s_and_b32 s9, s41, 0xffff
    s_mov_b32 s10, 1835008
    s_mov_b32 s11, 0x20000
    s_mov_b32 s4, s58
    s_and_b32 s5, s59, 0xffff
    s_mov_b32 s6, 268435456
    s_mov_b32 s7, 0x20000
    s_mov_b32 s24, s56
    s_mov_b32 s25, s57
    s_cmp_ge_u32 s28, 28
    s_cbranch_scc1 L_parallel_sum__softmax_full_mha__glu_gated_swiglu__prompt_kernel_helper
    s_lshl_b32 s37, s29, 7
    s_lshl_b32 s38, s26, 4
    s_add_u32 s37, s37, s38
    s_mul_i32 s81, s37, 896
    s_add_u32 s82, s81, 7168
    v_lshrrev_b32 v20, 3, v0
    v_and_b32 v21, 7, v0
    v_mul_u32_u24 v22, 896, v20
    v_lshlrev_b32 v23, 4, v21
    v_add_u32 v1, v22, v23
    s_add_u32 s37, s81, s60
    buffer_load_dwordx4 v[16:19], v1, s[8:11], s37 offen
    s_add_u32 s37, s81, s61
    buffer_load_dwordx4 v[20:23], v1, s[8:11], s37 offen
    s_add_u32 s37, s81, s62
    buffer_load_dwordx4 v[24:27], v1, s[8:11], s37 offen
    s_add_u32 s37, s81, s63
    buffer_load_dwordx4 v[28:31], v1, s[8:11], s37 offen
    s_mov_b32 s12, s42
    s_and_b32 s13, s43, 0xffff
    s_mov_b32 s14, 1204224
    s_mov_b32 s15, 0x20000
    s_and_b32 s37, s26, 3
    s_cmp_ge_u32 s37, 2
    s_cselect_b32 s16, s50, s48
    s_cselect_b32 s37, s51, s49
    s_and_b32 s17, s37, 0xffff
    s_mov_b32 s18, 1605632
    s_mov_b32 s19, 0x20000
    v_lshrrev_b32 v216, 3, v0
    v_and_b32 v217, 7, v0
    s_and_b32 s37, s26, 1
    v_xor_b32 v217, v217, v216
    v_xor_b32 v217, s37, v217
    v_lshlrev_b32 v217, 4, v217
    v_lshlrev_b32 v218, 7, v216
    v_add_u32 v217, v217, v218
    s_lshr_b32 s38, s26, 1
    s_mul_i32 s38, s38, 28672
    s_mul_i32 s39, s37, 14336
    s_add_u32 s38, s38, s39
    v_add_u32 v2, s38, v217
    s_lshl_b32 s38, s26, 6
    s_add_u32 s38, s38, 163328
    v_lshlrev_b32 v218, 2, v216
    v_add_u32 v3, s38, v218
    v_mov_b32 v128, 0x00003f80
    v_mov_b32 v129, 0x3f800000
    v_mov_b32 v130, 0x3f803f80
    s_and_b32 s34, s26, 3
    v_lshrrev_b32 v216, 4, v0
    v_and_b32 v217, 15, v0
    v_lshlrev_b32 v218, 2, v216
    v_xor_b32 v217, v217, v218
    v_lshlrev_b32 v217, 4, v217
    s_lshl_b32 s37, s34, 2
    v_add_u32 v216, s37, v216
    v_mul_u32_u24 v216, 2688, v216
    v_add_u32 v8, v216, v217
    v_lshrrev_b32 v216, 3, v0
    v_and_b32 v217, 7, v0
    v_bfe_u32 v218, v0, 4, 1
    s_lshr_b32 s37, s34, 1
    s_lshl_b32 s37, s37, 1
    v_or_b32 v218, s37, v218
    v_lshlrev_b32 v218, 1, v218
    v_xor_b32 v217, v217, v218
    v_lshlrev_b32 v217, 4, v217
    s_and_b32 s37, s34, 1
    s_lshl_b32 s37, s37, 3
    v_add_u32 v216, s37, v216
    v_mul_u32_u24 v216, 3584, v216
    v_add_u32 v9, v216, v217
    s_mul_i32 s36, s30, 192
    s_and_b32 s37, s30, 1
    s_lshl_b32 s38, s37, 6
    s_sub_u32 s36, s36, s38
    s_mul_i32 s38, s33, 43008
    s_add_u32 s36, s36, s38
    s_lshl_b32 s39, s30, 8
    s_mul_i32 s38, s33, 57344
    s_add_u32 s39, s39, s38
    s_lshl_b32 s83, s33, 12
    s_lshl_b32 s38, s34, 10
    s_add_u32 s83, s83, s38
    s_mul_i32 s37, s60, 1344
    s_add_u32 s67, s37, s36
    s_mul_i32 s37, s60, 1792
    s_add_u32 s74, s37, s39
    s_mul_i32 s37, s61, 1344
    s_add_u32 s68, s37, s36
    s_mul_i32 s37, s61, 1792
    s_add_u32 s75, s37, s39
    s_mul_i32 s37, s62, 1344
    s_add_u32 s69, s37, s36
    s_mul_i32 s37, s62, 1792
    s_add_u32 s76, s37, s39
    s_mul_i32 s37, s63, 1344
    s_add_u32 s70, s37, s36
    s_mul_i32 s37, s63, 1792
    s_add_u32 s77, s37, s39
    s_mul_i32 s37, s64, 1344
    s_add_u32 s71, s37, s36
    s_mul_i32 s37, s64, 1792
    s_add_u32 s78, s37, s39
    s_mul_i32 s37, s65, 1344
    s_add_u32 s72, s37, s36
    s_mul_i32 s37, s65, 1792
    s_add_u32 s79, s37, s39
    s_mul_i32 s37, s66, 1344
    s_add_u32 s73, s37, s36
    s_mul_i32 s37, s66, 1792
    s_add_u32 s80, s37, s39
    v_and_b32 v216, 31, v0
    v_lshrrev_b32 v217, 5, v0
    v_and_b32 v218, 7, v216
    v_lshrrev_b32 v219, 4, v216
    v_xor_b32 v219, v219, v218
    v_lshrrev_b32 v220, 3, v216
    v_mul_u32_u24 v220, 7168, v220
    v_lshlrev_b32 v218, 7, v218
    v_add_u32 v220, v220, v218
    s_mul_i32 s38, s32, 28672
    v_add_u32 v220, s38, v220
    v_add_u32 v221, 0, v217
    v_xor_b32 v221, v221, v219
    v_lshlrev_b32 v221, 4, v221
    v_add_u32 v4, v220, v221
    v_add_u32 v221, 2, v217
    v_xor_b32 v221, v221, v219
    v_lshlrev_b32 v221, 4, v221
    v_add_u32 v5, v220, v221
    v_add_u32 v221, 4, v217
    v_xor_b32 v221, v221, v219
    v_lshlrev_b32 v221, 4, v221
    v_add_u32 v6, v220, v221
    v_add_u32 v221, 6, v217
    v_xor_b32 v221, v221, v219
    v_lshlrev_b32 v221, 4, v221
    v_add_u32 v7, v220, v221
    v_bfe_u32 v216, v0, 2, 2
    v_lshrrev_b32 v217, 5, v0
    v_bfe_u32 v218, v0, 4, 1
    v_bfe_u32 v219, v0, 1, 1
    v_and_b32 v220, 1, v0
    v_lshl_add_u32 v221, v217, 3, v216
    v_lshlrev_b32 v221, 8, v221
    v_lshl_add_u32 v222, v218, 1, v219
    v_lshl_add_u32 v221, v222, 4, v221
    v_lshl_add_u32 v221, v220, 3, v221
    s_and_b32 s37, s30, 1
    s_lshl_b32 s38, s33, 1
    s_add_u32 s37, s37, s38
    s_add_u32 s38, s37, 0
    v_xor_b32 v222, s38, v216
    v_lshl_add_u32 v10, v222, 6, v221
    s_add_u32 s38, s37, 1
    v_xor_b32 v222, s38, v216
    v_lshl_add_u32 v11, v222, 6, v221
    v_lshl_add_u32 v221, v217, 3, v216
    v_lshlrev_b32 v221, 7, v221
    v_lshl_add_u32 v221, v218, 11, v221
    v_lshl_add_u32 v221, v219, 4, v221
    v_lshl_add_u32 v221, v220, 3, v221
    v_lshrrev_b32 v222, 1, v216
    v_lshl_or_b32 v222, v218, 1, v222
    s_lshl_b32 s37, s33, 1
    s_add_u32 s38, s37, 0
    v_xor_b32 v223, s38, v222
    v_lshl_add_u32 v12, v223, 5, v221
    s_add_u32 s38, s37, 1
    v_xor_b32 v223, s38, v222
    v_lshl_add_u32 v13, v223, 5, v221
    v_lshlrev_b32 v243, 4, v0
    v_and_b32 v222, 31, v0
    v_mul_u32_u24 v223, 7168, v217
    v_lshl_add_u32 v244, v222, 4, v223
    s_lshl_b32 s37, s26, 11
    s_add_u32 s37, s37, 147456
    v_bfe_u32 v223, v0, 1, 2
    v_lshlrev_b32 v245, 6, v222
    v_lshl_add_u32 v245, v217, 3, v245
    v_add_u32 v245, s37, v245
    v_lshlrev_b32 v247, 4, v223
    v_lshl_add_u32 v221, v217, 2, v216
    v_lshlrev_b32 v221, 6, v221
    v_lshl_add_u32 v222, v218, 1, v219
    v_lshrrev_b32 v223, 1, v216
    v_lshl_or_b32 v223, v217, 1, v223
    v_xor_b32 v222, v222, v223
    v_lshl_add_u32 v221, v222, 4, v221
    v_lshl_add_u32 v221, v220, 3, v221
    v_add_u32 v246, s37, v221
    s_mul_i32 s36, s30, 3
    s_lshl_b32 s37, s33, 1
    s_add_u32 s36, s36, s37
    s_add_u32 s87, s36, 0
    s_cmp_ge_u32 s87, 14
    s_cselect_b32 s89, 1.0, 0x3e8b97f6
    s_mul_i32 s36, s30, 3
    s_lshl_b32 s37, s33, 1
    s_add_u32 s36, s36, s37
    s_add_u32 s88, s36, 1
    s_cmp_ge_u32 s88, 14
    s_cselect_b32 s90, 1.0, 0x3e8b97f6
    s_mul_i32 s37, s35, 112
    s_lshl_b32 s38, s30, 3
    s_add_u32 s37, s37, s38
    s_lshl_b32 s38, s33, 1
    s_add_u32 s37, s37, s38
    s_lshl_b32 s86, s37, 10
    s_add_u32 s37, s81, s64
    buffer_load_dwordx4 v[32:35], v1, s[8:11], s37 offen
    s_add_u32 s37, s81, s65
    buffer_load_dwordx4 v[36:39], v1, s[8:11], s37 offen
    s_add_u32 s37, s81, s66
    buffer_load_dwordx4 v[40:43], v1, s[8:11], s37 offen
    s_waitcnt vmcnt(6)
    v_dot2_f32_bf16 v132, v16, v130, 0
    v_dot2_f32_bf16 v134, v16, v16, 0
    v_dot2_f32_bf16 v133, v17, v130, 0
    v_dot2_f32_bf16 v135, v17, v17, 0
    v_dot2_f32_bf16 v132, v18, v130, v132
    v_dot2_f32_bf16 v134, v18, v18, v134
    v_dot2_f32_bf16 v133, v19, v130, v133
    v_dot2_f32_bf16 v135, v19, v19, v135
    s_add_u32 s37, s82, s60
    buffer_load_dwordx4 v[44:47], v1, s[8:11], s37 offen
    s_waitcnt vmcnt(6)
    v_dot2_f32_bf16 v132, v20, v130, v132
    v_dot2_f32_bf16 v134, v20, v20, v134
    v_dot2_f32_bf16 v133, v21, v130, v133
    v_dot2_f32_bf16 v135, v21, v21, v135
    v_dot2_f32_bf16 v132, v22, v130, v132
    v_dot2_f32_bf16 v134, v22, v22, v134
    v_dot2_f32_bf16 v133, v23, v130, v133
    v_dot2_f32_bf16 v135, v23, v23, v135
    s_add_u32 s37, s82, s61
    buffer_load_dwordx4 v[48:51], v1, s[8:11], s37 offen
    s_waitcnt vmcnt(6)
    v_dot2_f32_bf16 v132, v24, v130, v132
    v_dot2_f32_bf16 v134, v24, v24, v134
    v_dot2_f32_bf16 v133, v25, v130, v133
    v_dot2_f32_bf16 v135, v25, v25, v135
    v_dot2_f32_bf16 v132, v26, v130, v132
    v_dot2_f32_bf16 v134, v26, v26, v134
    v_dot2_f32_bf16 v133, v27, v130, v133
    v_dot2_f32_bf16 v135, v27, v27, v135
    s_add_u32 s37, s82, s62
    buffer_load_dwordx4 v[52:55], v1, s[8:11], s37 offen
    s_waitcnt vmcnt(6)
    v_dot2_f32_bf16 v132, v28, v130, v132
    v_dot2_f32_bf16 v134, v28, v28, v134
    v_dot2_f32_bf16 v133, v29, v130, v133
    v_dot2_f32_bf16 v135, v29, v29, v135
    v_dot2_f32_bf16 v132, v30, v130, v132
    v_dot2_f32_bf16 v134, v30, v30, v134
    v_dot2_f32_bf16 v133, v31, v130, v133
    v_dot2_f32_bf16 v135, v31, v31, v135
    s_add_u32 s37, s82, s63
    buffer_load_dwordx4 v[56:59], v1, s[8:11], s37 offen
    s_waitcnt vmcnt(6)
    v_dot2_f32_bf16 v132, v32, v130, v132
    v_dot2_f32_bf16 v134, v32, v32, v134
    v_dot2_f32_bf16 v133, v33, v130, v133
    v_dot2_f32_bf16 v135, v33, v33, v135
    v_dot2_f32_bf16 v132, v34, v130, v132
    v_dot2_f32_bf16 v134, v34, v34, v134
    v_dot2_f32_bf16 v133, v35, v130, v133
    v_dot2_f32_bf16 v135, v35, v35, v135
    s_add_u32 s37, s82, s64
    buffer_load_dwordx4 v[60:63], v1, s[8:11], s37 offen
    s_waitcnt vmcnt(6)
    v_dot2_f32_bf16 v132, v36, v130, v132
    v_dot2_f32_bf16 v134, v36, v36, v134
    v_dot2_f32_bf16 v133, v37, v130, v133
    v_dot2_f32_bf16 v135, v37, v37, v135
    v_dot2_f32_bf16 v132, v38, v130, v132
    v_dot2_f32_bf16 v134, v38, v38, v134
    v_dot2_f32_bf16 v133, v39, v130, v133
    v_dot2_f32_bf16 v135, v39, v39, v135
    s_add_u32 s37, s82, s65
    buffer_load_dwordx4 v[64:67], v1, s[8:11], s37 offen
    s_waitcnt vmcnt(6)
    v_dot2_f32_bf16 v132, v40, v130, v132
    v_dot2_f32_bf16 v134, v40, v40, v134
    v_dot2_f32_bf16 v133, v41, v130, v133
    v_dot2_f32_bf16 v135, v41, v41, v135
    v_dot2_f32_bf16 v132, v42, v130, v132
    v_dot2_f32_bf16 v134, v42, v42, v134
    v_dot2_f32_bf16 v133, v43, v130, v133
    v_dot2_f32_bf16 v135, v43, v43, v135
    s_add_u32 s37, s82, s66
    buffer_load_dwordx4 v[68:71], v1, s[8:11], s37 offen
    s_nop 2
    v_add_f32 v132, v132, v133
    v_add_f32 v134, v134, v135
    s_nop 0
    v_add_f32_dpp v132, v132, v132 quad_perm:[1,0,3,2] row_mask:0xf bank_mask:0xf
    v_add_f32_dpp v134, v134, v134 quad_perm:[1,0,3,2] row_mask:0xf bank_mask:0xf
    s_nop 0
    v_add_f32_dpp v132, v132, v132 quad_perm:[2,3,0,1] row_mask:0xf bank_mask:0xf
    v_add_f32_dpp v134, v134, v134 quad_perm:[2,3,0,1] row_mask:0xf bank_mask:0xf
    s_nop 0
    v_add_f32_dpp v132, v132, v132 row_half_mirror row_mask:0xf bank_mask:0xf
    v_add_f32_dpp v134, v134, v134 row_half_mirror row_mask:0xf bank_mask:0xf
    v_mul_f32 v136, 0x3b124925, v132
    v_mul_f32 v137, 0x3b124925, v134
    v_fma_f32 v137, -v136, v136, v137
    v_max_f32 v137, 0, v137
    v_add_f32 v137, 0x3727c5ac, v137
    v_rsq_f32 v137, v137
    v_sub_f32 v136, 0, v136
    ds_write_b32 v3, v137 offset:0
    v_dot2_f32_bf16 v144, v16, v128, v136
    v_dot2_f32_bf16 v145, v16, v129, v136
    v_dot2_f32_bf16 v146, v17, v128, v136
    v_dot2_f32_bf16 v147, v17, v129, v136
    v_dot2_f32_bf16 v148, v18, v128, v136
    v_dot2_f32_bf16 v149, v18, v129, v136
    v_dot2_f32_bf16 v150, v19, v128, v136
    v_dot2_f32_bf16 v151, v19, v129, v136
    v_cvt_pk_bf16_f32 v16, v144, v145
    v_cvt_pk_bf16_f32 v17, v146, v147
    v_cvt_pk_bf16_f32 v18, v148, v149
    v_cvt_pk_bf16_f32 v19, v150, v151
    ds_write_b128 v2, v[16:19] offset:0
    v_dot2_f32_bf16 v144, v20, v128, v136
    v_dot2_f32_bf16 v145, v20, v129, v136
    v_dot2_f32_bf16 v146, v21, v128, v136
    v_dot2_f32_bf16 v147, v21, v129, v136
    v_dot2_f32_bf16 v148, v22, v128, v136
    v_dot2_f32_bf16 v149, v22, v129, v136
    v_dot2_f32_bf16 v150, v23, v128, v136
    v_dot2_f32_bf16 v151, v23, v129, v136
    v_cvt_pk_bf16_f32 v20, v144, v145
    v_cvt_pk_bf16_f32 v21, v146, v147
    v_cvt_pk_bf16_f32 v22, v148, v149
    v_cvt_pk_bf16_f32 v23, v150, v151
    ds_write_b128 v2, v[20:23] offset:1024
    v_dot2_f32_bf16 v144, v24, v128, v136
    v_dot2_f32_bf16 v145, v24, v129, v136
    v_dot2_f32_bf16 v146, v25, v128, v136
    v_dot2_f32_bf16 v147, v25, v129, v136
    v_dot2_f32_bf16 v148, v26, v128, v136
    v_dot2_f32_bf16 v149, v26, v129, v136
    v_dot2_f32_bf16 v150, v27, v128, v136
    v_dot2_f32_bf16 v151, v27, v129, v136
    v_cvt_pk_bf16_f32 v24, v144, v145
    v_cvt_pk_bf16_f32 v25, v146, v147
    v_cvt_pk_bf16_f32 v26, v148, v149
    v_cvt_pk_bf16_f32 v27, v150, v151
    ds_write_b128 v2, v[24:27] offset:2048
    v_dot2_f32_bf16 v144, v28, v128, v136
    v_dot2_f32_bf16 v145, v28, v129, v136
    v_dot2_f32_bf16 v146, v29, v128, v136
    v_dot2_f32_bf16 v147, v29, v129, v136
    v_dot2_f32_bf16 v148, v30, v128, v136
    v_dot2_f32_bf16 v149, v30, v129, v136
    v_dot2_f32_bf16 v150, v31, v128, v136
    v_dot2_f32_bf16 v151, v31, v129, v136
    v_cvt_pk_bf16_f32 v28, v144, v145
    v_cvt_pk_bf16_f32 v29, v146, v147
    v_cvt_pk_bf16_f32 v30, v148, v149
    v_cvt_pk_bf16_f32 v31, v150, v151
    ds_write_b128 v2, v[28:31] offset:3072
    v_dot2_f32_bf16 v144, v32, v128, v136
    v_dot2_f32_bf16 v145, v32, v129, v136
    v_dot2_f32_bf16 v146, v33, v128, v136
    v_dot2_f32_bf16 v147, v33, v129, v136
    v_dot2_f32_bf16 v148, v34, v128, v136
    v_dot2_f32_bf16 v149, v34, v129, v136
    v_dot2_f32_bf16 v150, v35, v128, v136
    v_dot2_f32_bf16 v151, v35, v129, v136
    v_cvt_pk_bf16_f32 v32, v144, v145
    v_cvt_pk_bf16_f32 v33, v146, v147
    v_cvt_pk_bf16_f32 v34, v148, v149
    v_cvt_pk_bf16_f32 v35, v150, v151
    ds_write_b128 v2, v[32:35] offset:4096
    v_dot2_f32_bf16 v144, v36, v128, v136
    v_dot2_f32_bf16 v145, v36, v129, v136
    v_dot2_f32_bf16 v146, v37, v128, v136
    v_dot2_f32_bf16 v147, v37, v129, v136
    v_dot2_f32_bf16 v148, v38, v128, v136
    v_dot2_f32_bf16 v149, v38, v129, v136
    v_dot2_f32_bf16 v150, v39, v128, v136
    v_dot2_f32_bf16 v151, v39, v129, v136
    v_cvt_pk_bf16_f32 v36, v144, v145
    v_cvt_pk_bf16_f32 v37, v146, v147
    v_cvt_pk_bf16_f32 v38, v148, v149
    v_cvt_pk_bf16_f32 v39, v150, v151
    ds_write_b128 v2, v[36:39] offset:5120
    v_dot2_f32_bf16 v144, v40, v128, v136
    v_dot2_f32_bf16 v145, v40, v129, v136
    v_dot2_f32_bf16 v146, v41, v128, v136
    v_dot2_f32_bf16 v147, v41, v129, v136
    v_dot2_f32_bf16 v148, v42, v128, v136
    v_dot2_f32_bf16 v149, v42, v129, v136
    v_dot2_f32_bf16 v150, v43, v128, v136
    v_dot2_f32_bf16 v151, v43, v129, v136
    v_cvt_pk_bf16_f32 v40, v144, v145
    v_cvt_pk_bf16_f32 v41, v146, v147
    v_cvt_pk_bf16_f32 v42, v148, v149
    v_cvt_pk_bf16_f32 v43, v150, v151
    ds_write_b128 v2, v[40:43] offset:6144
    s_waitcnt vmcnt(6)
    v_dot2_f32_bf16 v132, v44, v130, 0
    v_dot2_f32_bf16 v134, v44, v44, 0
    v_dot2_f32_bf16 v133, v45, v130, 0
    v_dot2_f32_bf16 v135, v45, v45, 0
    v_dot2_f32_bf16 v132, v46, v130, v132
    v_dot2_f32_bf16 v134, v46, v46, v134
    v_dot2_f32_bf16 v133, v47, v130, v133
    v_dot2_f32_bf16 v135, v47, v47, v135
    s_waitcnt vmcnt(5)
    v_dot2_f32_bf16 v132, v48, v130, v132
    v_dot2_f32_bf16 v134, v48, v48, v134
    v_dot2_f32_bf16 v133, v49, v130, v133
    v_dot2_f32_bf16 v135, v49, v49, v135
    v_dot2_f32_bf16 v132, v50, v130, v132
    v_dot2_f32_bf16 v134, v50, v50, v134
    v_dot2_f32_bf16 v133, v51, v130, v133
    v_dot2_f32_bf16 v135, v51, v51, v135
    s_waitcnt vmcnt(4)
    v_dot2_f32_bf16 v132, v52, v130, v132
    v_dot2_f32_bf16 v134, v52, v52, v134
    v_dot2_f32_bf16 v133, v53, v130, v133
    v_dot2_f32_bf16 v135, v53, v53, v135
    v_dot2_f32_bf16 v132, v54, v130, v132
    v_dot2_f32_bf16 v134, v54, v54, v134
    v_dot2_f32_bf16 v133, v55, v130, v133
    v_dot2_f32_bf16 v135, v55, v55, v135
    s_waitcnt vmcnt(3)
    v_dot2_f32_bf16 v132, v56, v130, v132
    v_dot2_f32_bf16 v134, v56, v56, v134
    v_dot2_f32_bf16 v133, v57, v130, v133
    v_dot2_f32_bf16 v135, v57, v57, v135
    v_dot2_f32_bf16 v132, v58, v130, v132
    v_dot2_f32_bf16 v134, v58, v58, v134
    v_dot2_f32_bf16 v133, v59, v130, v133
    v_dot2_f32_bf16 v135, v59, v59, v135
    s_waitcnt vmcnt(2)
    v_dot2_f32_bf16 v132, v60, v130, v132
    v_dot2_f32_bf16 v134, v60, v60, v134
    v_dot2_f32_bf16 v133, v61, v130, v133
    v_dot2_f32_bf16 v135, v61, v61, v135
    v_dot2_f32_bf16 v132, v62, v130, v132
    v_dot2_f32_bf16 v134, v62, v62, v134
    v_dot2_f32_bf16 v133, v63, v130, v133
    v_dot2_f32_bf16 v135, v63, v63, v135
    s_waitcnt vmcnt(1)
    v_dot2_f32_bf16 v132, v64, v130, v132
    v_dot2_f32_bf16 v134, v64, v64, v134
    v_dot2_f32_bf16 v133, v65, v130, v133
    v_dot2_f32_bf16 v135, v65, v65, v135
    v_dot2_f32_bf16 v132, v66, v130, v132
    v_dot2_f32_bf16 v134, v66, v66, v134
    v_dot2_f32_bf16 v133, v67, v130, v133
    v_dot2_f32_bf16 v135, v67, v67, v135
    s_waitcnt vmcnt(0)
    v_dot2_f32_bf16 v132, v68, v130, v132
    v_dot2_f32_bf16 v134, v68, v68, v134
    v_dot2_f32_bf16 v133, v69, v130, v133
    v_dot2_f32_bf16 v135, v69, v69, v135
    v_dot2_f32_bf16 v132, v70, v130, v132
    v_dot2_f32_bf16 v134, v70, v70, v134
    v_dot2_f32_bf16 v133, v71, v130, v133
    v_dot2_f32_bf16 v135, v71, v71, v135
    s_nop 2
    v_add_f32 v132, v132, v133
    v_add_f32 v134, v134, v135
    s_nop 0
    v_add_f32_dpp v132, v132, v132 quad_perm:[1,0,3,2] row_mask:0xf bank_mask:0xf
    v_add_f32_dpp v134, v134, v134 quad_perm:[1,0,3,2] row_mask:0xf bank_mask:0xf
    s_nop 0
    v_add_f32_dpp v132, v132, v132 quad_perm:[2,3,0,1] row_mask:0xf bank_mask:0xf
    v_add_f32_dpp v134, v134, v134 quad_perm:[2,3,0,1] row_mask:0xf bank_mask:0xf
    s_nop 0
    v_add_f32_dpp v132, v132, v132 row_half_mirror row_mask:0xf bank_mask:0xf
    v_add_f32_dpp v134, v134, v134 row_half_mirror row_mask:0xf bank_mask:0xf
    v_mul_f32 v136, 0x3b124925, v132
    v_mul_f32 v137, 0x3b124925, v134
    v_fma_f32 v137, -v136, v136, v137
    v_max_f32 v137, 0, v137
    v_add_f32 v137, 0x3727c5ac, v137
    v_rsq_f32 v137, v137
    v_sub_f32 v136, 0, v136
    ds_write_b32 v3, v137 offset:32
    v_dot2_f32_bf16 v144, v44, v128, v136
    v_dot2_f32_bf16 v145, v44, v129, v136
    v_dot2_f32_bf16 v146, v45, v128, v136
    v_dot2_f32_bf16 v147, v45, v129, v136
    v_dot2_f32_bf16 v148, v46, v128, v136
    v_dot2_f32_bf16 v149, v46, v129, v136
    v_dot2_f32_bf16 v150, v47, v128, v136
    v_dot2_f32_bf16 v151, v47, v129, v136
    v_cvt_pk_bf16_f32 v44, v144, v145
    v_cvt_pk_bf16_f32 v45, v146, v147
    v_cvt_pk_bf16_f32 v46, v148, v149
    v_cvt_pk_bf16_f32 v47, v150, v151
    ds_write_b128 v2, v[44:47] offset:7168
    v_dot2_f32_bf16 v144, v48, v128, v136
    v_dot2_f32_bf16 v145, v48, v129, v136
    v_dot2_f32_bf16 v146, v49, v128, v136
    v_dot2_f32_bf16 v147, v49, v129, v136
    v_dot2_f32_bf16 v148, v50, v128, v136
    v_dot2_f32_bf16 v149, v50, v129, v136
    v_dot2_f32_bf16 v150, v51, v128, v136
    v_dot2_f32_bf16 v151, v51, v129, v136
    v_cvt_pk_bf16_f32 v48, v144, v145
    v_cvt_pk_bf16_f32 v49, v146, v147
    v_cvt_pk_bf16_f32 v50, v148, v149
    v_cvt_pk_bf16_f32 v51, v150, v151
    ds_write_b128 v2, v[48:51] offset:8192
    v_dot2_f32_bf16 v144, v52, v128, v136
    v_dot2_f32_bf16 v145, v52, v129, v136
    v_dot2_f32_bf16 v146, v53, v128, v136
    v_dot2_f32_bf16 v147, v53, v129, v136
    v_dot2_f32_bf16 v148, v54, v128, v136
    v_dot2_f32_bf16 v149, v54, v129, v136
    v_dot2_f32_bf16 v150, v55, v128, v136
    v_dot2_f32_bf16 v151, v55, v129, v136
    v_cvt_pk_bf16_f32 v52, v144, v145
    v_cvt_pk_bf16_f32 v53, v146, v147
    v_cvt_pk_bf16_f32 v54, v148, v149
    v_cvt_pk_bf16_f32 v55, v150, v151
    ds_write_b128 v2, v[52:55] offset:9216
    v_dot2_f32_bf16 v144, v56, v128, v136
    v_dot2_f32_bf16 v145, v56, v129, v136
    v_dot2_f32_bf16 v146, v57, v128, v136
    v_dot2_f32_bf16 v147, v57, v129, v136
    v_dot2_f32_bf16 v148, v58, v128, v136
    v_dot2_f32_bf16 v149, v58, v129, v136
    v_dot2_f32_bf16 v150, v59, v128, v136
    v_dot2_f32_bf16 v151, v59, v129, v136
    v_cvt_pk_bf16_f32 v56, v144, v145
    v_cvt_pk_bf16_f32 v57, v146, v147
    v_cvt_pk_bf16_f32 v58, v148, v149
    v_cvt_pk_bf16_f32 v59, v150, v151
    ds_write_b128 v2, v[56:59] offset:10240
    v_dot2_f32_bf16 v144, v60, v128, v136
    v_dot2_f32_bf16 v145, v60, v129, v136
    v_dot2_f32_bf16 v146, v61, v128, v136
    v_dot2_f32_bf16 v147, v61, v129, v136
    v_dot2_f32_bf16 v148, v62, v128, v136
    v_dot2_f32_bf16 v149, v62, v129, v136
    v_dot2_f32_bf16 v150, v63, v128, v136
    v_dot2_f32_bf16 v151, v63, v129, v136
    v_cvt_pk_bf16_f32 v60, v144, v145
    v_cvt_pk_bf16_f32 v61, v146, v147
    v_cvt_pk_bf16_f32 v62, v148, v149
    v_cvt_pk_bf16_f32 v63, v150, v151
    ds_write_b128 v2, v[60:63] offset:11264
    v_dot2_f32_bf16 v144, v64, v128, v136
    v_dot2_f32_bf16 v145, v64, v129, v136
    v_dot2_f32_bf16 v146, v65, v128, v136
    v_dot2_f32_bf16 v147, v65, v129, v136
    v_dot2_f32_bf16 v148, v66, v128, v136
    v_dot2_f32_bf16 v149, v66, v129, v136
    v_dot2_f32_bf16 v150, v67, v128, v136
    v_dot2_f32_bf16 v151, v67, v129, v136
    v_cvt_pk_bf16_f32 v64, v144, v145
    v_cvt_pk_bf16_f32 v65, v146, v147
    v_cvt_pk_bf16_f32 v66, v148, v149
    v_cvt_pk_bf16_f32 v67, v150, v151
    ds_write_b128 v2, v[64:67] offset:12288
    v_dot2_f32_bf16 v144, v68, v128, v136
    v_dot2_f32_bf16 v145, v68, v129, v136
    v_dot2_f32_bf16 v146, v69, v128, v136
    v_dot2_f32_bf16 v147, v69, v129, v136
    v_dot2_f32_bf16 v148, v70, v128, v136
    v_dot2_f32_bf16 v149, v70, v129, v136
    v_dot2_f32_bf16 v150, v71, v128, v136
    v_dot2_f32_bf16 v151, v71, v129, v136
    v_cvt_pk_bf16_f32 v68, v144, v145
    v_cvt_pk_bf16_f32 v69, v146, v147
    v_cvt_pk_bf16_f32 v70, v148, v149
    v_cvt_pk_bf16_f32 v71, v150, v151
    ds_write_b128 v2, v[68:71] offset:13312
    s_cmp_eq_u32 s33, 0
    s_cbranch_scc0 L_parallel_sum__softmax_full_mha__glu_gated_swiglu__prompt_kernel_pdma
    s_add_u32 m0, s83, 114688
    s_add_u32 s36, s67, 0
    buffer_load_dwordx4 v8, s[12:15], s36 offen lds
    s_add_u32 m0, s83, 118784
    s_add_u32 s36, s67, 43008
    buffer_load_dwordx4 v8, s[12:15], s36 offen lds
    s_add_u32 m0, s83, 122880
    s_add_u32 s36, s67, 86016
    buffer_load_dwordx4 v8, s[12:15], s36 offen lds
    s_add_u32 m0, s83, 126976
    s_add_u32 s36, s67, 129024
    buffer_load_dwordx4 v8, s[12:15], s36 offen lds
    s_add_u32 m0, s83, 131072
    s_add_u32 s36, s68, 0
    buffer_load_dwordx4 v8, s[12:15], s36 offen lds
    s_add_u32 m0, s83, 135168
    s_add_u32 s36, s68, 43008
    buffer_load_dwordx4 v8, s[12:15], s36 offen lds
    s_add_u32 m0, s83, 139264
    s_add_u32 s36, s68, 86016
    buffer_load_dwordx4 v8, s[12:15], s36 offen lds
    s_add_u32 m0, s83, 143360
    s_add_u32 s36, s68, 129024
    buffer_load_dwordx4 v8, s[12:15], s36 offen lds
    s_add_u32 m0, s83, 147456
    s_add_u32 s36, s69, 0
    buffer_load_dwordx4 v8, s[12:15], s36 offen lds
    s_add_u32 m0, s83, 151552
    s_add_u32 s36, s69, 43008
    buffer_load_dwordx4 v8, s[12:15], s36 offen lds
L_parallel_sum__softmax_full_mha__glu_gated_swiglu__prompt_kernel_pdma:
    s_waitcnt lgkmcnt(0)
    s_barrier
    ds_read_b128 v[16:19], v4 offset:0
    ds_read_b128 v[20:23], v5 offset:0
    ds_read_b128 v[24:27], v6 offset:0
    ds_read_b128 v[28:31], v7 offset:0
    ds_read_b128 v[32:35], v4 offset:1024
    ds_read_b128 v[36:39], v5 offset:1024
    ds_read_b128 v[40:43], v6 offset:1024
    ds_read_b128 v[44:47], v7 offset:1024
    ds_read_b128 v[48:51], v4 offset:2048
    ds_read_b128 v[52:55], v5 offset:2048
    ds_read_b128 v[56:59], v6 offset:2048
    ds_read_b128 v[60:63], v7 offset:2048
    ds_read_b128 v[64:67], v4 offset:3072
    ds_read_b128 v[68:71], v5 offset:3072
    ds_read_b128 v[72:75], v6 offset:3072
    ds_read_b128 v[76:79], v7 offset:3072
    ds_read_b128 v[80:83], v4 offset:4096
    ds_read_b128 v[84:87], v5 offset:4096
    ds_read_b128 v[88:91], v6 offset:4096
    ds_read_b128 v[92:95], v7 offset:4096
    ds_read_b128 v[96:99], v4 offset:5120
    ds_read_b128 v[100:103], v5 offset:5120
    ds_read_b128 v[104:107], v6 offset:5120
    ds_read_b128 v[108:111], v7 offset:5120
    ds_read_b128 v[112:115], v4 offset:6144
    ds_read_b128 v[116:119], v5 offset:6144
    ds_read_b128 v[120:123], v6 offset:6144
    ds_read_b128 v[124:127], v7 offset:6144
    v_and_b32 v216, 31, v0
    s_lshl_b32 s37, s32, 7
    s_add_u32 s37, s37, 163328
    v_lshlrev_b32 v216, 2, v216
    v_add_u32 v216, s37, v216
    ds_read_b32 v240, v216
    s_waitcnt lgkmcnt(0)
    v_mul_f32 v241, 0xbfb8aa3b, v240
    v_mul_f32 v242, v240, v240
    s_waitcnt vmcnt(0)
    s_barrier
    s_cmp_eq_u32 s33, 0
    s_cbranch_scc0 L_parallel_sum__softmax_full_mha__glu_gated_swiglu__prompt_kernel_q1
    v_add_u32 v14, 114688, v10
    v_add_u32 v15, 114688, v11
    ds_read_b64_tr_b16 v[192:193], v14 offset:0
    ds_read_b64_tr_b16 v[194:195], v14 offset:1024
    ds_read_b64_tr_b16 v[196:197], v15 offset:0
    ds_read_b64_tr_b16 v[198:199], v15 offset:1024
    ds_read_b64_tr_b16 v[200:201], v14 offset:4096
    ds_read_b64_tr_b16 v[202:203], v14 offset:5120
    ds_read_b64_tr_b16 v[204:205], v15 offset:4096
    ds_read_b64_tr_b16 v[206:207], v15 offset:5120
    s_waitcnt lgkmcnt(4)
    v_mfma_f32_32x32x16_bf16 v[128:143], v[192:195], v[16:19], 0
    ds_read_b64_tr_b16 v[208:209], v14 offset:8192
    ds_read_b64_tr_b16 v[210:211], v14 offset:9216
    ds_read_b64_tr_b16 v[212:213], v15 offset:8192
    ds_read_b64_tr_b16 v[214:215], v15 offset:9216
    s_add_u32 m0, s83, 155648
    s_add_u32 s36, s69, 86016
    buffer_load_dwordx4 v8, s[12:15], s36 offen lds
    s_add_u32 m0, s83, 0
    s_add_u32 s36, s70, 0
    buffer_load_dwordx4 v8, s[12:15], s36 offen lds
    s_add_u32 m0, s83, 8192
    s_add_u32 s36, s70, 86016
    buffer_load_dwordx4 v8, s[12:15], s36 offen lds
    v_mfma_f32_32x32x16_bf16 v[144:159], v[196:199], v[16:19], 0
    s_waitcnt lgkmcnt(4)
    v_mfma_f32_32x32x16_bf16 v[128:143], v[200:203], v[20:23], v[128:143]
    ds_read_b64_tr_b16 v[192:193], v14 offset:12288
    ds_read_b64_tr_b16 v[194:195], v14 offset:13312
    ds_read_b64_tr_b16 v[196:197], v15 offset:12288
    ds_read_b64_tr_b16 v[198:199], v15 offset:13312
    s_add_u32 m0, s83, 16384
    s_add_u32 s36, s71, 0
    buffer_load_dwordx4 v8, s[12:15], s36 offen lds
    s_add_u32 m0, s83, 24576
    s_add_u32 s36, s71, 86016
    buffer_load_dwordx4 v8, s[12:15], s36 offen lds
    v_mfma_f32_32x32x16_bf16 v[144:159], v[204:207], v[20:23], v[144:159]
    s_waitcnt lgkmcnt(4)
    v_mfma_f32_32x32x16_bf16 v[128:143], v[208:211], v[24:27], v[128:143]
    v_add_u32 v14, 131072, v10
    v_add_u32 v15, 131072, v11
    ds_read_b64_tr_b16 v[200:201], v14 offset:0
    ds_read_b64_tr_b16 v[202:203], v14 offset:1024
    ds_read_b64_tr_b16 v[204:205], v15 offset:0
    ds_read_b64_tr_b16 v[206:207], v15 offset:1024
    s_add_u32 m0, s83, 32768
    s_add_u32 s36, s72, 0
    buffer_load_dwordx4 v8, s[12:15], s36 offen lds
    s_add_u32 m0, s83, 40960
    s_add_u32 s36, s72, 86016
    buffer_load_dwordx4 v8, s[12:15], s36 offen lds
    v_mfma_f32_32x32x16_bf16 v[144:159], v[212:215], v[24:27], v[144:159]
    s_waitcnt lgkmcnt(4)
    v_mfma_f32_32x32x16_bf16 v[128:143], v[192:195], v[28:31], v[128:143]
    ds_read_b64_tr_b16 v[208:209], v14 offset:4096
    ds_read_b64_tr_b16 v[210:211], v14 offset:5120
    ds_read_b64_tr_b16 v[212:213], v15 offset:4096
    ds_read_b64_tr_b16 v[214:215], v15 offset:5120
    v_mfma_f32_32x32x16_bf16 v[144:159], v[196:199], v[28:31], v[144:159]
    s_waitcnt vmcnt(6)
    s_barrier
    s_waitcnt lgkmcnt(4)
    v_mfma_f32_32x32x16_bf16 v[128:143], v[200:203], v[32:35], v[128:143]
    ds_read_b64_tr_b16 v[192:193], v14 offset:8192
    ds_read_b64_tr_b16 v[194:195], v14 offset:9216
    ds_read_b64_tr_b16 v[196:197], v15 offset:8192
    ds_read_b64_tr_b16 v[198:199], v15 offset:9216
    s_add_u32 m0, s83, 49152
    s_add_u32 s36, s73, 0
    buffer_load_dwordx4 v8, s[12:15], s36 offen lds
    v_mfma_f32_32x32x16_bf16 v[144:159], v[204:207], v[32:35], v[144:159]
    s_waitcnt lgkmcnt(4)
    v_mfma_f32_32x32x16_bf16 v[128:143], v[208:211], v[36:39], v[128:143]
    ds_read_b64_tr_b16 v[200:201], v14 offset:12288
    ds_read_b64_tr_b16 v[202:203], v14 offset:13312
    ds_read_b64_tr_b16 v[204:205], v15 offset:12288
    ds_read_b64_tr_b16 v[206:207], v15 offset:13312
    s_add_u32 m0, s83, 57344
    s_add_u32 s36, s73, 86016
    buffer_load_dwordx4 v8, s[12:15], s36 offen lds
    v_mfma_f32_32x32x16_bf16 v[144:159], v[212:215], v[36:39], v[144:159]
    s_waitcnt lgkmcnt(4)
    v_mfma_f32_32x32x16_bf16 v[128:143], v[192:195], v[40:43], v[128:143]
    v_add_u32 v14, 147456, v10
    v_add_u32 v15, 147456, v11
    ds_read_b64_tr_b16 v[208:209], v14 offset:0
    ds_read_b64_tr_b16 v[210:211], v14 offset:1024
    ds_read_b64_tr_b16 v[212:213], v15 offset:0
    ds_read_b64_tr_b16 v[214:215], v15 offset:1024
    v_mfma_f32_32x32x16_bf16 v[144:159], v[196:199], v[40:43], v[144:159]
    s_waitcnt lgkmcnt(4)
    v_mfma_f32_32x32x16_bf16 v[128:143], v[200:203], v[44:47], v[128:143]
    ds_read_b64_tr_b16 v[192:193], v14 offset:4096
    ds_read_b64_tr_b16 v[194:195], v14 offset:5120
    ds_read_b64_tr_b16 v[196:197], v15 offset:4096
    ds_read_b64_tr_b16 v[198:199], v15 offset:5120
    v_mfma_f32_32x32x16_bf16 v[144:159], v[204:207], v[44:47], v[144:159]
    s_waitcnt vmcnt(6)
    s_barrier
    s_waitcnt lgkmcnt(4)
    v_mfma_f32_32x32x16_bf16 v[128:143], v[208:211], v[48:51], v[128:143]
    ds_read_b64_tr_b16 v[200:201], v14 offset:8192
    ds_read_b64_tr_b16 v[202:203], v14 offset:9216
    ds_read_b64_tr_b16 v[204:205], v15 offset:8192
    ds_read_b64_tr_b16 v[206:207], v15 offset:9216
    s_add_u32 m0, s83, 65536
    s_add_u32 s36, s74, 0
    buffer_load_dwordx4 v9, s[16:19], s36 offen lds
    v_mfma_f32_32x32x16_bf16 v[144:159], v[212:215], v[48:51], v[144:159]
    s_waitcnt lgkmcnt(4)
    v_mfma_f32_32x32x16_bf16 v[128:143], v[192:195], v[52:55], v[128:143]
    ds_read_b64_tr_b16 v[208:209], v14 offset:12288
    ds_read_b64_tr_b16 v[210:211], v14 offset:13312
    ds_read_b64_tr_b16 v[212:213], v15 offset:12288
    ds_read_b64_tr_b16 v[214:215], v15 offset:13312
    s_add_u32 m0, s83, 73728
    s_add_u32 s36, s74, 114688
    buffer_load_dwordx4 v9, s[16:19], s36 offen lds
    v_mfma_f32_32x32x16_bf16 v[144:159], v[196:199], v[52:55], v[144:159]
    s_waitcnt lgkmcnt(4)
    v_mfma_f32_32x32x16_bf16 v[128:143], v[200:203], v[56:59], v[128:143]
    v_add_u32 v14, 0, v10
    v_add_u32 v15, 0, v11
    ds_read_b64_tr_b16 v[192:193], v14 offset:0
    ds_read_b64_tr_b16 v[194:195], v14 offset:1024
    ds_read_b64_tr_b16 v[196:197], v15 offset:0
    ds_read_b64_tr_b16 v[198:199], v15 offset:1024
    v_mfma_f32_32x32x16_bf16 v[144:159], v[204:207], v[56:59], v[144:159]
    s_waitcnt lgkmcnt(4)
    v_mfma_f32_32x32x16_bf16 v[128:143], v[208:211], v[60:63], v[128:143]
    ds_read_b64_tr_b16 v[200:201], v14 offset:4096
    ds_read_b64_tr_b16 v[202:203], v14 offset:5120
    ds_read_b64_tr_b16 v[204:205], v15 offset:4096
    ds_read_b64_tr_b16 v[206:207], v15 offset:5120
    v_mfma_f32_32x32x16_bf16 v[144:159], v[212:215], v[60:63], v[144:159]
    s_waitcnt vmcnt(6)
    s_barrier
    s_waitcnt lgkmcnt(4)
    v_mfma_f32_32x32x16_bf16 v[128:143], v[192:195], v[64:67], v[128:143]
    ds_read_b64_tr_b16 v[208:209], v14 offset:8192
    ds_read_b64_tr_b16 v[210:211], v14 offset:9216
    ds_read_b64_tr_b16 v[212:213], v15 offset:8192
    ds_read_b64_tr_b16 v[214:215], v15 offset:9216
    s_add_u32 m0, s83, 81920
    s_add_u32 s36, s75, 0
    buffer_load_dwordx4 v9, s[16:19], s36 offen lds
    v_mfma_f32_32x32x16_bf16 v[144:159], v[196:199], v[64:67], v[144:159]
    s_waitcnt lgkmcnt(4)
    v_mfma_f32_32x32x16_bf16 v[128:143], v[200:203], v[68:71], v[128:143]
    ds_read_b64_tr_b16 v[192:193], v14 offset:12288
    ds_read_b64_tr_b16 v[194:195], v14 offset:13312
    ds_read_b64_tr_b16 v[196:197], v15 offset:12288
    ds_read_b64_tr_b16 v[198:199], v15 offset:13312
    s_add_u32 m0, s83, 90112
    s_add_u32 s36, s75, 114688
    buffer_load_dwordx4 v9, s[16:19], s36 offen lds
    v_mfma_f32_32x32x16_bf16 v[144:159], v[204:207], v[68:71], v[144:159]
    s_waitcnt lgkmcnt(4)
    v_mfma_f32_32x32x16_bf16 v[128:143], v[208:211], v[72:75], v[128:143]
    v_add_u32 v14, 16384, v10
    v_add_u32 v15, 16384, v11
    ds_read_b64_tr_b16 v[200:201], v14 offset:0
    ds_read_b64_tr_b16 v[202:203], v14 offset:1024
    ds_read_b64_tr_b16 v[204:205], v15 offset:0
    ds_read_b64_tr_b16 v[206:207], v15 offset:1024
    v_mfma_f32_32x32x16_bf16 v[144:159], v[212:215], v[72:75], v[144:159]
    s_waitcnt lgkmcnt(4)
    v_mfma_f32_32x32x16_bf16 v[128:143], v[192:195], v[76:79], v[128:143]
    ds_read_b64_tr_b16 v[208:209], v14 offset:4096
    ds_read_b64_tr_b16 v[210:211], v14 offset:5120
    ds_read_b64_tr_b16 v[212:213], v15 offset:4096
    ds_read_b64_tr_b16 v[214:215], v15 offset:5120
    v_mfma_f32_32x32x16_bf16 v[144:159], v[196:199], v[76:79], v[144:159]
    s_waitcnt vmcnt(6)
    s_barrier
    s_waitcnt lgkmcnt(4)
    v_mfma_f32_32x32x16_bf16 v[128:143], v[200:203], v[80:83], v[128:143]
    ds_read_b64_tr_b16 v[192:193], v14 offset:8192
    ds_read_b64_tr_b16 v[194:195], v14 offset:9216
    ds_read_b64_tr_b16 v[196:197], v15 offset:8192
    ds_read_b64_tr_b16 v[198:199], v15 offset:9216
    s_add_u32 m0, s83, 98304
    s_add_u32 s36, s76, 0
    buffer_load_dwordx4 v9, s[16:19], s36 offen lds
    v_mfma_f32_32x32x16_bf16 v[144:159], v[204:207], v[80:83], v[144:159]
    s_waitcnt lgkmcnt(4)
    v_mfma_f32_32x32x16_bf16 v[128:143], v[208:211], v[84:87], v[128:143]
    ds_read_b64_tr_b16 v[200:201], v14 offset:12288
    ds_read_b64_tr_b16 v[202:203], v14 offset:13312
    ds_read_b64_tr_b16 v[204:205], v15 offset:12288
    ds_read_b64_tr_b16 v[206:207], v15 offset:13312
    s_add_u32 m0, s83, 106496
    s_add_u32 s36, s76, 114688
    buffer_load_dwordx4 v9, s[16:19], s36 offen lds
    v_mfma_f32_32x32x16_bf16 v[144:159], v[212:215], v[84:87], v[144:159]
    s_waitcnt lgkmcnt(4)
    v_mfma_f32_32x32x16_bf16 v[128:143], v[192:195], v[88:91], v[128:143]
    v_add_u32 v14, 32768, v10
    v_add_u32 v15, 32768, v11
    ds_read_b64_tr_b16 v[208:209], v14 offset:0
    ds_read_b64_tr_b16 v[210:211], v14 offset:1024
    ds_read_b64_tr_b16 v[212:213], v15 offset:0
    ds_read_b64_tr_b16 v[214:215], v15 offset:1024
    v_mfma_f32_32x32x16_bf16 v[144:159], v[196:199], v[88:91], v[144:159]
    s_waitcnt lgkmcnt(4)
    v_mfma_f32_32x32x16_bf16 v[128:143], v[200:203], v[92:95], v[128:143]
    ds_read_b64_tr_b16 v[192:193], v14 offset:4096
    ds_read_b64_tr_b16 v[194:195], v14 offset:5120
    ds_read_b64_tr_b16 v[196:197], v15 offset:4096
    ds_read_b64_tr_b16 v[198:199], v15 offset:5120
    v_mfma_f32_32x32x16_bf16 v[144:159], v[204:207], v[92:95], v[144:159]
    s_waitcnt vmcnt(6)
    s_barrier
    s_waitcnt lgkmcnt(4)
    v_mfma_f32_32x32x16_bf16 v[128:143], v[208:211], v[96:99], v[128:143]
    ds_read_b64_tr_b16 v[200:201], v14 offset:8192
    ds_read_b64_tr_b16 v[202:203], v14 offset:9216
    ds_read_b64_tr_b16 v[204:205], v15 offset:8192
    ds_read_b64_tr_b16 v[206:207], v15 offset:9216
    s_add_u32 m0, s83, 114688
    s_add_u32 s36, s77, 0
    buffer_load_dwordx4 v9, s[16:19], s36 offen lds
    v_mfma_f32_32x32x16_bf16 v[144:159], v[212:215], v[96:99], v[144:159]
    s_waitcnt lgkmcnt(4)
    v_mfma_f32_32x32x16_bf16 v[128:143], v[192:195], v[100:103], v[128:143]
    ds_read_b64_tr_b16 v[208:209], v14 offset:12288
    ds_read_b64_tr_b16 v[210:211], v14 offset:13312
    ds_read_b64_tr_b16 v[212:213], v15 offset:12288
    ds_read_b64_tr_b16 v[214:215], v15 offset:13312
    s_add_u32 m0, s83, 122880
    s_add_u32 s36, s77, 114688
    buffer_load_dwordx4 v9, s[16:19], s36 offen lds
    v_mfma_f32_32x32x16_bf16 v[144:159], v[196:199], v[100:103], v[144:159]
    s_waitcnt lgkmcnt(4)
    v_mfma_f32_32x32x16_bf16 v[128:143], v[200:203], v[104:107], v[128:143]
    v_add_u32 v14, 49152, v10
    v_add_u32 v15, 49152, v11
    ds_read_b64_tr_b16 v[192:193], v14 offset:0
    ds_read_b64_tr_b16 v[194:195], v14 offset:1024
    ds_read_b64_tr_b16 v[196:197], v15 offset:0
    ds_read_b64_tr_b16 v[198:199], v15 offset:1024
    v_mfma_f32_32x32x16_bf16 v[144:159], v[204:207], v[104:107], v[144:159]
    s_waitcnt lgkmcnt(4)
    v_mfma_f32_32x32x16_bf16 v[128:143], v[208:211], v[108:111], v[128:143]
    ds_read_b64_tr_b16 v[200:201], v14 offset:4096
    ds_read_b64_tr_b16 v[202:203], v14 offset:5120
    ds_read_b64_tr_b16 v[204:205], v15 offset:4096
    ds_read_b64_tr_b16 v[206:207], v15 offset:5120
    v_mfma_f32_32x32x16_bf16 v[144:159], v[212:215], v[108:111], v[144:159]
    s_waitcnt vmcnt(6)
    s_barrier
    s_waitcnt lgkmcnt(4)
    v_mfma_f32_32x32x16_bf16 v[128:143], v[192:195], v[112:115], v[128:143]
    ds_read_b64_tr_b16 v[208:209], v14 offset:8192
    ds_read_b64_tr_b16 v[210:211], v14 offset:9216
    ds_read_b64_tr_b16 v[212:213], v15 offset:8192
    ds_read_b64_tr_b16 v[214:215], v15 offset:9216
    s_add_u32 m0, s83, 131072
    s_add_u32 s36, s78, 0
    buffer_load_dwordx4 v9, s[16:19], s36 offen lds
    v_mfma_f32_32x32x16_bf16 v[144:159], v[196:199], v[112:115], v[144:159]
    s_waitcnt lgkmcnt(4)
    v_mfma_f32_32x32x16_bf16 v[128:143], v[200:203], v[116:119], v[128:143]
    ds_read_b64_tr_b16 v[192:193], v14 offset:12288
    ds_read_b64_tr_b16 v[194:195], v14 offset:13312
    ds_read_b64_tr_b16 v[196:197], v15 offset:12288
    ds_read_b64_tr_b16 v[198:199], v15 offset:13312
    s_add_u32 m0, s83, 139264
    s_add_u32 s36, s78, 114688
    buffer_load_dwordx4 v9, s[16:19], s36 offen lds
    v_mfma_f32_32x32x16_bf16 v[144:159], v[204:207], v[116:119], v[144:159]
    s_waitcnt lgkmcnt(4)
    v_mfma_f32_32x32x16_bf16 v[128:143], v[208:211], v[120:123], v[128:143]
    v_add_u32 v14, 65536, v12
    v_add_u32 v15, 65536, v13
    ds_read_b64_tr_b16 v[200:201], v14 offset:0
    ds_read_b64_tr_b16 v[202:203], v14 offset:512
    ds_read_b64_tr_b16 v[204:205], v15 offset:0
    ds_read_b64_tr_b16 v[206:207], v15 offset:512
    v_mfma_f32_32x32x16_bf16 v[144:159], v[212:215], v[120:123], v[144:159]
    s_waitcnt lgkmcnt(4)
    v_mfma_f32_32x32x16_bf16 v[128:143], v[192:195], v[124:127], v[128:143]
    ds_read_b64_tr_b16 v[208:209], v14 offset:4096
    ds_read_b64_tr_b16 v[210:211], v14 offset:4608
    ds_read_b64_tr_b16 v[212:213], v15 offset:4096
    ds_read_b64_tr_b16 v[214:215], v15 offset:4608
    v_mfma_f32_32x32x16_bf16 v[144:159], v[196:199], v[124:127], v[144:159]
    s_branch L_parallel_sum__softmax_full_mha__glu_gated_swiglu__prompt_kernel_ffn
L_parallel_sum__softmax_full_mha__glu_gated_swiglu__prompt_kernel_q1:
    v_add_u32 v14, 114688, v10
    ds_read_b64_tr_b16 v[192:193], v14 offset:0
    ds_read_b64_tr_b16 v[194:195], v14 offset:1024
    ds_read_b64_tr_b16 v[200:201], v14 offset:4096
    ds_read_b64_tr_b16 v[202:203], v14 offset:5120
    s_waitcnt lgkmcnt(2)
    v_mfma_f32_32x32x16_bf16 v[128:143], v[192:195], v[16:19], 0
    ds_read_b64_tr_b16 v[208:209], v14 offset:8192
    ds_read_b64_tr_b16 v[210:211], v14 offset:9216
    s_add_u32 m0, s83, 155648
    s_add_u32 s36, s69, 86016
    buffer_load_dwordx4 v8, s[12:15], s36 offen lds
    s_add_u32 m0, s83, 0
    s_add_u32 s36, s70, 0
    buffer_load_dwordx4 v8, s[12:15], s36 offen lds
    s_add_u32 m0, s83, 8192
    s_add_u32 s36, s70, 86016
    buffer_load_dwordx4 v8, s[12:15], s36 offen lds
    s_waitcnt lgkmcnt(2)
    v_mfma_f32_32x32x16_bf16 v[128:143], v[200:203], v[20:23], v[128:143]
    ds_read_b64_tr_b16 v[192:193], v14 offset:12288
    ds_read_b64_tr_b16 v[194:195], v14 offset:13312
    s_add_u32 m0, s83, 16384
    s_add_u32 s36, s71, 0
    buffer_load_dwordx4 v8, s[12:15], s36 offen lds
    s_add_u32 m0, s83, 24576
    s_add_u32 s36, s71, 86016
    buffer_load_dwordx4 v8, s[12:15], s36 offen lds
    s_waitcnt lgkmcnt(2)
    v_mfma_f32_32x32x16_bf16 v[128:143], v[208:211], v[24:27], v[128:143]
    v_add_u32 v14, 131072, v10
    ds_read_b64_tr_b16 v[200:201], v14 offset:0
    ds_read_b64_tr_b16 v[202:203], v14 offset:1024
    s_add_u32 m0, s83, 32768
    s_add_u32 s36, s72, 0
    buffer_load_dwordx4 v8, s[12:15], s36 offen lds
    s_add_u32 m0, s83, 40960
    s_add_u32 s36, s72, 86016
    buffer_load_dwordx4 v8, s[12:15], s36 offen lds
    s_waitcnt lgkmcnt(2)
    v_mfma_f32_32x32x16_bf16 v[128:143], v[192:195], v[28:31], v[128:143]
    ds_read_b64_tr_b16 v[208:209], v14 offset:4096
    ds_read_b64_tr_b16 v[210:211], v14 offset:5120
    s_waitcnt vmcnt(6)
    s_barrier
    s_waitcnt lgkmcnt(2)
    v_mfma_f32_32x32x16_bf16 v[128:143], v[200:203], v[32:35], v[128:143]
    ds_read_b64_tr_b16 v[192:193], v14 offset:8192
    ds_read_b64_tr_b16 v[194:195], v14 offset:9216
    s_add_u32 m0, s83, 49152
    s_add_u32 s36, s73, 0
    buffer_load_dwordx4 v8, s[12:15], s36 offen lds
    s_waitcnt lgkmcnt(2)
    v_mfma_f32_32x32x16_bf16 v[128:143], v[208:211], v[36:39], v[128:143]
    ds_read_b64_tr_b16 v[200:201], v14 offset:12288
    ds_read_b64_tr_b16 v[202:203], v14 offset:13312
    s_add_u32 m0, s83, 57344
    s_add_u32 s36, s73, 86016
    buffer_load_dwordx4 v8, s[12:15], s36 offen lds
    s_waitcnt lgkmcnt(2)
    v_mfma_f32_32x32x16_bf16 v[128:143], v[192:195], v[40:43], v[128:143]
    v_add_u32 v14, 147456, v10
    ds_read_b64_tr_b16 v[208:209], v14 offset:0
    ds_read_b64_tr_b16 v[210:211], v14 offset:1024
    s_waitcnt lgkmcnt(2)
    v_mfma_f32_32x32x16_bf16 v[128:143], v[200:203], v[44:47], v[128:143]
    ds_read_b64_tr_b16 v[192:193], v14 offset:4096
    ds_read_b64_tr_b16 v[194:195], v14 offset:5120
    s_waitcnt vmcnt(6)
    s_barrier
    s_waitcnt lgkmcnt(2)
    v_mfma_f32_32x32x16_bf16 v[128:143], v[208:211], v[48:51], v[128:143]
    ds_read_b64_tr_b16 v[200:201], v14 offset:8192
    ds_read_b64_tr_b16 v[202:203], v14 offset:9216
    s_add_u32 m0, s83, 65536
    s_add_u32 s36, s74, 0
    buffer_load_dwordx4 v9, s[16:19], s36 offen lds
    s_waitcnt lgkmcnt(2)
    v_mfma_f32_32x32x16_bf16 v[128:143], v[192:195], v[52:55], v[128:143]
    ds_read_b64_tr_b16 v[208:209], v14 offset:12288
    ds_read_b64_tr_b16 v[210:211], v14 offset:13312
    s_add_u32 m0, s83, 73728
    s_add_u32 s36, s74, 114688
    buffer_load_dwordx4 v9, s[16:19], s36 offen lds
    s_waitcnt lgkmcnt(2)
    v_mfma_f32_32x32x16_bf16 v[128:143], v[200:203], v[56:59], v[128:143]
    v_add_u32 v14, 0, v10
    ds_read_b64_tr_b16 v[192:193], v14 offset:0
    ds_read_b64_tr_b16 v[194:195], v14 offset:1024
    s_waitcnt lgkmcnt(2)
    v_mfma_f32_32x32x16_bf16 v[128:143], v[208:211], v[60:63], v[128:143]
    ds_read_b64_tr_b16 v[200:201], v14 offset:4096
    ds_read_b64_tr_b16 v[202:203], v14 offset:5120
    s_waitcnt vmcnt(6)
    s_barrier
    s_waitcnt lgkmcnt(2)
    v_mfma_f32_32x32x16_bf16 v[128:143], v[192:195], v[64:67], v[128:143]
    ds_read_b64_tr_b16 v[208:209], v14 offset:8192
    ds_read_b64_tr_b16 v[210:211], v14 offset:9216
    s_add_u32 m0, s83, 81920
    s_add_u32 s36, s75, 0
    buffer_load_dwordx4 v9, s[16:19], s36 offen lds
    s_waitcnt lgkmcnt(2)
    v_mfma_f32_32x32x16_bf16 v[128:143], v[200:203], v[68:71], v[128:143]
    ds_read_b64_tr_b16 v[192:193], v14 offset:12288
    ds_read_b64_tr_b16 v[194:195], v14 offset:13312
    s_add_u32 m0, s83, 90112
    s_add_u32 s36, s75, 114688
    buffer_load_dwordx4 v9, s[16:19], s36 offen lds
    s_waitcnt lgkmcnt(2)
    v_mfma_f32_32x32x16_bf16 v[128:143], v[208:211], v[72:75], v[128:143]
    v_add_u32 v14, 16384, v10
    ds_read_b64_tr_b16 v[200:201], v14 offset:0
    ds_read_b64_tr_b16 v[202:203], v14 offset:1024
    s_waitcnt lgkmcnt(2)
    v_mfma_f32_32x32x16_bf16 v[128:143], v[192:195], v[76:79], v[128:143]
    ds_read_b64_tr_b16 v[208:209], v14 offset:4096
    ds_read_b64_tr_b16 v[210:211], v14 offset:5120
    s_waitcnt vmcnt(6)
    s_barrier
    s_waitcnt lgkmcnt(2)
    v_mfma_f32_32x32x16_bf16 v[128:143], v[200:203], v[80:83], v[128:143]
    ds_read_b64_tr_b16 v[192:193], v14 offset:8192
    ds_read_b64_tr_b16 v[194:195], v14 offset:9216
    s_add_u32 m0, s83, 98304
    s_add_u32 s36, s76, 0
    buffer_load_dwordx4 v9, s[16:19], s36 offen lds
    s_waitcnt lgkmcnt(2)
    v_mfma_f32_32x32x16_bf16 v[128:143], v[208:211], v[84:87], v[128:143]
    ds_read_b64_tr_b16 v[200:201], v14 offset:12288
    ds_read_b64_tr_b16 v[202:203], v14 offset:13312
    s_add_u32 m0, s83, 106496
    s_add_u32 s36, s76, 114688
    buffer_load_dwordx4 v9, s[16:19], s36 offen lds
    s_waitcnt lgkmcnt(2)
    v_mfma_f32_32x32x16_bf16 v[128:143], v[192:195], v[88:91], v[128:143]
    v_add_u32 v14, 32768, v10
    ds_read_b64_tr_b16 v[208:209], v14 offset:0
    ds_read_b64_tr_b16 v[210:211], v14 offset:1024
    s_waitcnt lgkmcnt(2)
    v_mfma_f32_32x32x16_bf16 v[128:143], v[200:203], v[92:95], v[128:143]
    ds_read_b64_tr_b16 v[192:193], v14 offset:4096
    ds_read_b64_tr_b16 v[194:195], v14 offset:5120
    s_waitcnt vmcnt(6)
    s_barrier
    s_waitcnt lgkmcnt(2)
    v_mfma_f32_32x32x16_bf16 v[128:143], v[208:211], v[96:99], v[128:143]
    ds_read_b64_tr_b16 v[200:201], v14 offset:8192
    ds_read_b64_tr_b16 v[202:203], v14 offset:9216
    s_add_u32 m0, s83, 114688
    s_add_u32 s36, s77, 0
    buffer_load_dwordx4 v9, s[16:19], s36 offen lds
    s_waitcnt lgkmcnt(2)
    v_mfma_f32_32x32x16_bf16 v[128:143], v[192:195], v[100:103], v[128:143]
    ds_read_b64_tr_b16 v[208:209], v14 offset:12288
    ds_read_b64_tr_b16 v[210:211], v14 offset:13312
    s_add_u32 m0, s83, 122880
    s_add_u32 s36, s77, 114688
    buffer_load_dwordx4 v9, s[16:19], s36 offen lds
    s_waitcnt lgkmcnt(2)
    v_mfma_f32_32x32x16_bf16 v[128:143], v[200:203], v[104:107], v[128:143]
    v_add_u32 v14, 49152, v10
    ds_read_b64_tr_b16 v[192:193], v14 offset:0
    ds_read_b64_tr_b16 v[194:195], v14 offset:1024
    s_waitcnt lgkmcnt(2)
    v_mfma_f32_32x32x16_bf16 v[128:143], v[208:211], v[108:111], v[128:143]
    ds_read_b64_tr_b16 v[200:201], v14 offset:4096
    ds_read_b64_tr_b16 v[202:203], v14 offset:5120
    s_waitcnt vmcnt(6)
    s_barrier
    s_waitcnt lgkmcnt(2)
    v_mfma_f32_32x32x16_bf16 v[128:143], v[192:195], v[112:115], v[128:143]
    ds_read_b64_tr_b16 v[208:209], v14 offset:8192
    ds_read_b64_tr_b16 v[210:211], v14 offset:9216
    s_add_u32 m0, s83, 131072
    s_add_u32 s36, s78, 0
    buffer_load_dwordx4 v9, s[16:19], s36 offen lds
    s_waitcnt lgkmcnt(2)
    v_mfma_f32_32x32x16_bf16 v[128:143], v[200:203], v[116:119], v[128:143]
    ds_read_b64_tr_b16 v[192:193], v14 offset:12288
    ds_read_b64_tr_b16 v[194:195], v14 offset:13312
    s_add_u32 m0, s83, 139264
    s_add_u32 s36, s78, 114688
    buffer_load_dwordx4 v9, s[16:19], s36 offen lds
    s_waitcnt lgkmcnt(2)
    v_mfma_f32_32x32x16_bf16 v[128:143], v[208:211], v[120:123], v[128:143]
    v_add_u32 v14, 65536, v12
    v_add_u32 v15, 65536, v13
    ds_read_b64_tr_b16 v[200:201], v14 offset:0
    ds_read_b64_tr_b16 v[202:203], v14 offset:512
    ds_read_b64_tr_b16 v[204:205], v15 offset:0
    ds_read_b64_tr_b16 v[206:207], v15 offset:512
    s_waitcnt lgkmcnt(4)
    v_mfma_f32_32x32x16_bf16 v[128:143], v[192:195], v[124:127], v[128:143]
    ds_read_b64_tr_b16 v[208:209], v14 offset:4096
    ds_read_b64_tr_b16 v[210:211], v14 offset:4608
    ds_read_b64_tr_b16 v[212:213], v15 offset:4096
    ds_read_b64_tr_b16 v[214:215], v15 offset:4608
L_parallel_sum__softmax_full_mha__glu_gated_swiglu__prompt_kernel_ffn:
    s_waitcnt vmcnt(6)
    s_barrier
    s_waitcnt lgkmcnt(4)
    v_mfma_f32_32x32x16_bf16 v[160:175], v[200:203], v[16:19], 0
    ds_read_b64_tr_b16 v[192:193], v14 offset:8192
    ds_read_b64_tr_b16 v[194:195], v14 offset:8704
    ds_read_b64_tr_b16 v[196:197], v15 offset:8192
    ds_read_b64_tr_b16 v[198:199], v15 offset:8704
    s_add_u32 m0, s83, 0
    s_add_u32 s36, s79, 0
    buffer_load_dwordx4 v9, s[16:19], s36 offen lds
    v_mfma_f32_32x32x16_bf16 v[176:191], v[204:207], v[16:19], 0
    s_waitcnt lgkmcnt(4)
    v_mfma_f32_32x32x16_bf16 v[160:175], v[208:211], v[20:23], v[160:175]
    ds_read_b64_tr_b16 v[200:201], v14 offset:12288
    ds_read_b64_tr_b16 v[202:203], v14 offset:12800
    ds_read_b64_tr_b16 v[204:205], v15 offset:12288
    ds_read_b64_tr_b16 v[206:207], v15 offset:12800
    s_add_u32 m0, s83, 8192
    s_add_u32 s36, s79, 114688
    buffer_load_dwordx4 v9, s[16:19], s36 offen lds
    v_mfma_f32_32x32x16_bf16 v[176:191], v[212:215], v[20:23], v[176:191]
    s_waitcnt lgkmcnt(4)
    v_mfma_f32_32x32x16_bf16 v[160:175], v[192:195], v[24:27], v[160:175]
    v_add_u32 v14, 81920, v12
    v_add_u32 v15, 81920, v13
    ds_read_b64_tr_b16 v[208:209], v14 offset:0
    ds_read_b64_tr_b16 v[210:211], v14 offset:512
    ds_read_b64_tr_b16 v[212:213], v15 offset:0
    ds_read_b64_tr_b16 v[214:215], v15 offset:512
    v_mul_f32 v248, s89, v240
    v_mul_f32 v128, v248, v128
    v_mul_f32 v129, v248, v129
    v_mul_f32 v130, v248, v130
    v_mul_f32 v131, v248, v131
    v_mul_f32 v132, v248, v132
    v_mul_f32 v133, v248, v133
    v_mul_f32 v134, v248, v134
    v_mul_f32 v135, v248, v135
    v_mul_f32 v136, v248, v136
    v_mfma_f32_32x32x16_bf16 v[176:191], v[196:199], v[24:27], v[176:191]
    s_waitcnt lgkmcnt(4)
    v_mfma_f32_32x32x16_bf16 v[160:175], v[200:203], v[28:31], v[160:175]
    ds_read_b64_tr_b16 v[192:193], v14 offset:4096
    ds_read_b64_tr_b16 v[194:195], v14 offset:4608
    ds_read_b64_tr_b16 v[196:197], v15 offset:4096
    ds_read_b64_tr_b16 v[198:199], v15 offset:4608
    v_mul_f32 v137, v248, v137
    v_mul_f32 v138, v248, v138
    v_mul_f32 v139, v248, v139
    v_mul_f32 v140, v248, v140
    v_mul_f32 v141, v248, v141
    v_mul_f32 v142, v248, v142
    v_mul_f32 v143, v248, v143
    v_cvt_pk_bf16_f32 v216, v128, v129
    v_cvt_pk_bf16_f32 v217, v130, v131
    v_cvt_pk_bf16_f32 v218, v132, v133
    v_mfma_f32_32x32x16_bf16 v[176:191], v[204:207], v[28:31], v[176:191]
    s_waitcnt vmcnt(6)
    s_barrier
    s_waitcnt lgkmcnt(4)
    v_mfma_f32_32x32x16_bf16 v[160:175], v[208:211], v[32:35], v[160:175]
    ds_read_b64_tr_b16 v[200:201], v14 offset:8192
    ds_read_b64_tr_b16 v[202:203], v14 offset:8704
    ds_read_b64_tr_b16 v[204:205], v15 offset:8192
    ds_read_b64_tr_b16 v[206:207], v15 offset:8704
    s_add_u32 m0, s83, 16384
    s_add_u32 s36, s80, 0
    buffer_load_dwordx4 v9, s[16:19], s36 offen lds
    v_cvt_pk_bf16_f32 v219, v134, v135
    v_cvt_pk_bf16_f32 v220, v136, v137
    v_cvt_pk_bf16_f32 v221, v138, v139
    v_cvt_pk_bf16_f32 v222, v140, v141
    v_cvt_pk_bf16_f32 v223, v142, v143
    v_mul_f32 v248, s90, v240
    v_mul_f32 v144, v248, v144
    v_mul_f32 v145, v248, v145
    v_mul_f32 v146, v248, v146
    v_mul_f32 v147, v248, v147
    v_mfma_f32_32x32x16_bf16 v[176:191], v[212:215], v[32:35], v[176:191]
    s_waitcnt lgkmcnt(4)
    v_mfma_f32_32x32x16_bf16 v[160:175], v[192:195], v[36:39], v[160:175]
    ds_read_b64_tr_b16 v[208:209], v14 offset:12288
    ds_read_b64_tr_b16 v[210:211], v14 offset:12800
    ds_read_b64_tr_b16 v[212:213], v15 offset:12288
    ds_read_b64_tr_b16 v[214:215], v15 offset:12800
    s_add_u32 m0, s83, 24576
    s_add_u32 s36, s80, 114688
    buffer_load_dwordx4 v9, s[16:19], s36 offen lds
    v_mul_f32 v148, v248, v148
    v_mul_f32 v149, v248, v149
    v_mul_f32 v150, v248, v150
    v_mul_f32 v151, v248, v151
    v_mul_f32 v152, v248, v152
    v_mul_f32 v153, v248, v153
    v_mul_f32 v154, v248, v154
    v_mul_f32 v155, v248, v155
    v_mul_f32 v156, v248, v156
    v_mul_f32 v157, v248, v157
    v_mfma_f32_32x32x16_bf16 v[176:191], v[196:199], v[36:39], v[176:191]
    s_waitcnt lgkmcnt(4)
    v_mfma_f32_32x32x16_bf16 v[160:175], v[200:203], v[40:43], v[160:175]
    v_add_u32 v14, 98304, v12
    v_add_u32 v15, 98304, v13
    ds_read_b64_tr_b16 v[192:193], v14 offset:0
    ds_read_b64_tr_b16 v[194:195], v14 offset:512
    ds_read_b64_tr_b16 v[196:197], v15 offset:0
    ds_read_b64_tr_b16 v[198:199], v15 offset:512
    v_mul_f32 v158, v248, v158
    v_mul_f32 v159, v248, v159
    v_cvt_pk_bf16_f32 v224, v144, v145
    v_cvt_pk_bf16_f32 v225, v146, v147
    v_cvt_pk_bf16_f32 v226, v148, v149
    v_cvt_pk_bf16_f32 v227, v150, v151
    v_cvt_pk_bf16_f32 v228, v152, v153
    v_cvt_pk_bf16_f32 v229, v154, v155
    v_cvt_pk_bf16_f32 v230, v156, v157
    v_cvt_pk_bf16_f32 v231, v158, v159
    v_mfma_f32_32x32x16_bf16 v[176:191], v[204:207], v[40:43], v[176:191]
    s_waitcnt lgkmcnt(4)
    v_mfma_f32_32x32x16_bf16 v[160:175], v[208:211], v[44:47], v[160:175]
    ds_read_b64_tr_b16 v[200:201], v14 offset:4096
    ds_read_b64_tr_b16 v[202:203], v14 offset:4608
    ds_read_b64_tr_b16 v[204:205], v15 offset:4096
    ds_read_b64_tr_b16 v[206:207], v15 offset:4608
    v_mfma_f32_32x32x16_bf16 v[176:191], v[212:215], v[44:47], v[176:191]
    s_cmp_eq_u32 s26, 0
    s_cbranch_scc0 L_parallel_sum__softmax_full_mha__glu_gated_swiglu__prompt_kernel_e36
    v_mov_b32 v1, 0
    global_load_dword v2, v1, s[24:25] sc1
L_parallel_sum__softmax_full_mha__glu_gated_swiglu__prompt_kernel_e36:
    s_cmp_eq_u32 s33, 1
    s_cbranch_scc0 L_parallel_sum__softmax_full_mha__glu_gated_swiglu__prompt_kernel_qts1
    s_cmp_ge_u32 s87, 28
    s_cbranch_scc1 L_parallel_sum__softmax_full_mha__glu_gated_swiglu__prompt_kernel_qt10_v
    s_cmp_ge_u32 s87, 14
    s_cselect_b32 s37, 14, 0
    s_cselect_b32 s38, 0x1c0000, 0
    s_add_u32 s38, s38, 0x700000
    s_sub_u32 s37, s87, s37
    s_lshl_b32 s37, s37, 11
    s_add_u32 s38, s38, s37
    s_mul_i32 s37, s35, 28672
    s_add_u32 s84, s38, s37
    v_permlane32_swap_b32 v216, v218
    v_permlane32_swap_b32 v217, v219
    v_permlane32_swap_b32 v220, v222
    v_permlane32_swap_b32 v221, v223
    buffer_store_dwordx4 v[216:219], v243, s[4:7], s84 offen offset:0 sc1
    buffer_store_dwordx4 v[220:223], v243, s[4:7], s84 offen offset:1024 sc1
    s_branch L_parallel_sum__softmax_full_mha__glu_gated_swiglu__prompt_kernel_qt10_done
L_parallel_sum__softmax_full_mha__glu_gated_swiglu__prompt_kernel_qt10_v:
    s_sub_u32 s37, s87, 28
    s_lshl_b32 s37, s37, 9
    s_mul_i32 s38, s35, 28672
    s_add_u32 s37, s37, s38
    s_add_u32 s84, s37, 0xa80000
    s_add_u32 s85, s84, 14336
    v_xor_b32 v232, 0, v247
    v_add_u32 v232, v245, v232
    ds_write_b64 v232, v[216:217]
    v_xor_b32 v232, 16, v247
    v_add_u32 v232, v245, v232
    ds_write_b64 v232, v[218:219]
    v_xor_b32 v232, 32, v247
    v_add_u32 v232, v245, v232
    ds_write_b64 v232, v[220:221]
    v_xor_b32 v232, 48, v247
    v_add_u32 v232, v245, v232
    ds_write_b64 v232, v[222:223]
    s_waitcnt lgkmcnt(0)
    ds_read_b64_tr_b16 v[216:217], v246 offset:0
    ds_read_b64_tr_b16 v[218:219], v246 offset:512
    ds_read_b64_tr_b16 v[220:221], v246 offset:1024
    ds_read_b64_tr_b16 v[222:223], v246 offset:1536
    s_waitcnt lgkmcnt(0)
    buffer_store_dwordx4 v[216:219], v244, s[4:7], s84 offen sc1
    buffer_store_dwordx4 v[220:223], v244, s[4:7], s85 offen sc1
L_parallel_sum__softmax_full_mha__glu_gated_swiglu__prompt_kernel_qt10_done:
L_parallel_sum__softmax_full_mha__glu_gated_swiglu__prompt_kernel_qts1:
    s_waitcnt vmcnt(6)
    s_barrier
    s_waitcnt lgkmcnt(4)
    v_mfma_f32_32x32x16_bf16 v[160:175], v[192:195], v[48:51], v[160:175]
    ds_read_b64_tr_b16 v[208:209], v14 offset:8192
    ds_read_b64_tr_b16 v[210:211], v14 offset:8704
    ds_read_b64_tr_b16 v[212:213], v15 offset:8192
    ds_read_b64_tr_b16 v[214:215], v15 offset:8704
    s_add_u32 m0, s83, 32768
    s_add_u32 s36, s74, 128
    buffer_load_dwordx4 v9, s[16:19], s36 offen lds
    v_mfma_f32_32x32x16_bf16 v[176:191], v[196:199], v[48:51], v[176:191]
    s_waitcnt lgkmcnt(4)
    v_mfma_f32_32x32x16_bf16 v[160:175], v[200:203], v[52:55], v[160:175]
    ds_read_b64_tr_b16 v[192:193], v14 offset:12288
    ds_read_b64_tr_b16 v[194:195], v14 offset:12800
    ds_read_b64_tr_b16 v[196:197], v15 offset:12288
    ds_read_b64_tr_b16 v[198:199], v15 offset:12800
    s_add_u32 m0, s83, 40960
    s_add_u32 s36, s74, 114816
    buffer_load_dwordx4 v9, s[16:19], s36 offen lds
    v_mfma_f32_32x32x16_bf16 v[176:191], v[204:207], v[52:55], v[176:191]
    s_waitcnt lgkmcnt(4)
    v_mfma_f32_32x32x16_bf16 v[160:175], v[208:211], v[56:59], v[160:175]
    v_add_u32 v14, 114688, v12
    v_add_u32 v15, 114688, v13
    ds_read_b64_tr_b16 v[200:201], v14 offset:0
    ds_read_b64_tr_b16 v[202:203], v14 offset:512
    ds_read_b64_tr_b16 v[204:205], v15 offset:0
    ds_read_b64_tr_b16 v[206:207], v15 offset:512
    v_mfma_f32_32x32x16_bf16 v[176:191], v[212:215], v[56:59], v[176:191]
    s_waitcnt lgkmcnt(4)
    v_mfma_f32_32x32x16_bf16 v[160:175], v[192:195], v[60:63], v[160:175]
    ds_read_b64_tr_b16 v[208:209], v14 offset:4096
    ds_read_b64_tr_b16 v[210:211], v14 offset:4608
    ds_read_b64_tr_b16 v[212:213], v15 offset:4096
    ds_read_b64_tr_b16 v[214:215], v15 offset:4608
    v_mfma_f32_32x32x16_bf16 v[176:191], v[196:199], v[60:63], v[176:191]
    s_cmp_eq_u32 s33, 0
    s_cbranch_scc0 L_parallel_sum__softmax_full_mha__glu_gated_swiglu__prompt_kernel_qts0
    s_cmp_ge_u32 s87, 28
    s_cbranch_scc1 L_parallel_sum__softmax_full_mha__glu_gated_swiglu__prompt_kernel_qt00_v
    s_cmp_ge_u32 s87, 14
    s_cselect_b32 s37, 14, 0
    s_cselect_b32 s38, 0x1c0000, 0
    s_add_u32 s38, s38, 0x700000
    s_sub_u32 s37, s87, s37
    s_lshl_b32 s37, s37, 11
    s_add_u32 s38, s38, s37
    s_mul_i32 s37, s35, 28672
    s_add_u32 s84, s38, s37
    v_permlane32_swap_b32 v216, v218
    v_permlane32_swap_b32 v217, v219
    v_permlane32_swap_b32 v220, v222
    v_permlane32_swap_b32 v221, v223
    buffer_store_dwordx4 v[216:219], v243, s[4:7], s84 offen offset:0 sc1
    buffer_store_dwordx4 v[220:223], v243, s[4:7], s84 offen offset:1024 sc1
    s_branch L_parallel_sum__softmax_full_mha__glu_gated_swiglu__prompt_kernel_qt00_done
L_parallel_sum__softmax_full_mha__glu_gated_swiglu__prompt_kernel_qt00_v:
    s_sub_u32 s37, s87, 28
    s_lshl_b32 s37, s37, 9
    s_mul_i32 s38, s35, 28672
    s_add_u32 s37, s37, s38
    s_add_u32 s84, s37, 0xa80000
    s_add_u32 s85, s84, 14336
    v_xor_b32 v232, 0, v247
    v_add_u32 v232, v245, v232
    ds_write_b64 v232, v[216:217]
    v_xor_b32 v232, 16, v247
    v_add_u32 v232, v245, v232
    ds_write_b64 v232, v[218:219]
    v_xor_b32 v232, 32, v247
    v_add_u32 v232, v245, v232
    ds_write_b64 v232, v[220:221]
    v_xor_b32 v232, 48, v247
    v_add_u32 v232, v245, v232
    ds_write_b64 v232, v[222:223]
    s_waitcnt lgkmcnt(0)
    ds_read_b64_tr_b16 v[216:217], v246 offset:0
    ds_read_b64_tr_b16 v[218:219], v246 offset:512
    ds_read_b64_tr_b16 v[220:221], v246 offset:1024
    ds_read_b64_tr_b16 v[222:223], v246 offset:1536
    s_waitcnt lgkmcnt(0)
    buffer_store_dwordx4 v[216:219], v244, s[4:7], s84 offen sc1
    buffer_store_dwordx4 v[220:223], v244, s[4:7], s85 offen sc1
L_parallel_sum__softmax_full_mha__glu_gated_swiglu__prompt_kernel_qt00_done:
    s_cmp_ge_u32 s88, 28
    s_cbranch_scc1 L_parallel_sum__softmax_full_mha__glu_gated_swiglu__prompt_kernel_qt01_v
    s_cmp_ge_u32 s88, 14
    s_cselect_b32 s37, 14, 0
    s_cselect_b32 s38, 0x1c0000, 0
    s_add_u32 s38, s38, 0x700000
    s_sub_u32 s37, s88, s37
    s_lshl_b32 s37, s37, 11
    s_add_u32 s38, s38, s37
    s_mul_i32 s37, s35, 28672
    s_add_u32 s84, s38, s37
    v_permlane32_swap_b32 v224, v226
    v_permlane32_swap_b32 v225, v227
    v_permlane32_swap_b32 v228, v230
    v_permlane32_swap_b32 v229, v231
    buffer_store_dwordx4 v[224:227], v243, s[4:7], s84 offen offset:0 sc1
    buffer_store_dwordx4 v[228:231], v243, s[4:7], s84 offen offset:1024 sc1
    s_branch L_parallel_sum__softmax_full_mha__glu_gated_swiglu__prompt_kernel_qt01_done
L_parallel_sum__softmax_full_mha__glu_gated_swiglu__prompt_kernel_qt01_v:
    s_sub_u32 s37, s88, 28
    s_lshl_b32 s37, s37, 9
    s_mul_i32 s38, s35, 28672
    s_add_u32 s37, s37, s38
    s_add_u32 s84, s37, 0xa80000
    s_add_u32 s85, s84, 14336
    v_xor_b32 v232, 0, v247
    v_add_u32 v232, v245, v232
    ds_write_b64 v232, v[224:225]
    v_xor_b32 v232, 16, v247
    v_add_u32 v232, v245, v232
    ds_write_b64 v232, v[226:227]
    v_xor_b32 v232, 32, v247
    v_add_u32 v232, v245, v232
    ds_write_b64 v232, v[228:229]
    v_xor_b32 v232, 48, v247
    v_add_u32 v232, v245, v232
    ds_write_b64 v232, v[230:231]
    s_waitcnt lgkmcnt(0)
    ds_read_b64_tr_b16 v[224:225], v246 offset:0
    ds_read_b64_tr_b16 v[226:227], v246 offset:512
    ds_read_b64_tr_b16 v[228:229], v246 offset:1024
    ds_read_b64_tr_b16 v[230:231], v246 offset:1536
    s_waitcnt lgkmcnt(0)
    buffer_store_dwordx4 v[224:227], v244, s[4:7], s84 offen sc1
    buffer_store_dwordx4 v[228:231], v244, s[4:7], s85 offen sc1
L_parallel_sum__softmax_full_mha__glu_gated_swiglu__prompt_kernel_qt01_done:
L_parallel_sum__softmax_full_mha__glu_gated_swiglu__prompt_kernel_qts0:
    s_waitcnt vmcnt(6)
    s_barrier
    s_waitcnt lgkmcnt(4)
    v_mfma_f32_32x32x16_bf16 v[160:175], v[200:203], v[64:67], v[160:175]
    ds_read_b64_tr_b16 v[192:193], v14 offset:8192
    ds_read_b64_tr_b16 v[194:195], v14 offset:8704
    ds_read_b64_tr_b16 v[196:197], v15 offset:8192
    ds_read_b64_tr_b16 v[198:199], v15 offset:8704
    s_add_u32 m0, s83, 49152
    s_add_u32 s36, s75, 128
    buffer_load_dwordx4 v9, s[16:19], s36 offen lds
    v_mfma_f32_32x32x16_bf16 v[176:191], v[204:207], v[64:67], v[176:191]
    s_waitcnt lgkmcnt(4)
    v_mfma_f32_32x32x16_bf16 v[160:175], v[208:211], v[68:71], v[160:175]
    ds_read_b64_tr_b16 v[200:201], v14 offset:12288
    ds_read_b64_tr_b16 v[202:203], v14 offset:12800
    ds_read_b64_tr_b16 v[204:205], v15 offset:12288
    ds_read_b64_tr_b16 v[206:207], v15 offset:12800
    s_add_u32 m0, s83, 57344
    s_add_u32 s36, s75, 114816
    buffer_load_dwordx4 v9, s[16:19], s36 offen lds
    v_mfma_f32_32x32x16_bf16 v[176:191], v[212:215], v[68:71], v[176:191]
    s_waitcnt lgkmcnt(4)
    v_mfma_f32_32x32x16_bf16 v[160:175], v[192:195], v[72:75], v[160:175]
    v_add_u32 v14, 131072, v12
    v_add_u32 v15, 131072, v13
    ds_read_b64_tr_b16 v[208:209], v14 offset:0
    ds_read_b64_tr_b16 v[210:211], v14 offset:512
    ds_read_b64_tr_b16 v[212:213], v15 offset:0
    ds_read_b64_tr_b16 v[214:215], v15 offset:512
    v_mfma_f32_32x32x16_bf16 v[176:191], v[196:199], v[72:75], v[176:191]
    s_waitcnt lgkmcnt(4)
    v_mfma_f32_32x32x16_bf16 v[160:175], v[200:203], v[76:79], v[160:175]
    ds_read_b64_tr_b16 v[192:193], v14 offset:4096
    ds_read_b64_tr_b16 v[194:195], v14 offset:4608
    ds_read_b64_tr_b16 v[196:197], v15 offset:4096
    ds_read_b64_tr_b16 v[198:199], v15 offset:4608
    v_mfma_f32_32x32x16_bf16 v[176:191], v[204:207], v[76:79], v[176:191]
    s_waitcnt vmcnt(6)
    s_barrier
    s_cmp_eq_u32 s26, 0
    s_cbranch_scc0 L_parallel_sum__softmax_full_mha__glu_gated_swiglu__prompt_kernel_e44
    v_mov_b32 v228, 163328
    v_mov_b32 v224, 0
    v_mov_b32 v225, 0
    v_mov_b32 v226, 0
    v_mov_b32 v227, 0
    ds_write_b128 v228, v[224:227]
    ds_write_b128 v228, v[224:227] offset:16
L_parallel_sum__softmax_full_mha__glu_gated_swiglu__prompt_kernel_e44:
    s_waitcnt lgkmcnt(4)
    v_mfma_f32_32x32x16_bf16 v[160:175], v[208:211], v[80:83], v[160:175]
    ds_read_b64_tr_b16 v[200:201], v14 offset:8192
    ds_read_b64_tr_b16 v[202:203], v14 offset:8704
    ds_read_b64_tr_b16 v[204:205], v15 offset:8192
    ds_read_b64_tr_b16 v[206:207], v15 offset:8704
    s_add_u32 m0, s83, 65536
    s_add_u32 s36, s76, 128
    buffer_load_dwordx4 v9, s[16:19], s36 offen lds
    v_mfma_f32_32x32x16_bf16 v[176:191], v[212:215], v[80:83], v[176:191]
    s_waitcnt lgkmcnt(4)
    v_mfma_f32_32x32x16_bf16 v[160:175], v[192:195], v[84:87], v[160:175]
    ds_read_b64_tr_b16 v[208:209], v14 offset:12288
    ds_read_b64_tr_b16 v[210:211], v14 offset:12800
    ds_read_b64_tr_b16 v[212:213], v15 offset:12288
    ds_read_b64_tr_b16 v[214:215], v15 offset:12800
    s_add_u32 m0, s83, 73728
    s_add_u32 s36, s76, 114816
    buffer_load_dwordx4 v9, s[16:19], s36 offen lds
    v_mfma_f32_32x32x16_bf16 v[176:191], v[196:199], v[84:87], v[176:191]
    s_waitcnt lgkmcnt(4)
    v_mfma_f32_32x32x16_bf16 v[160:175], v[200:203], v[88:91], v[160:175]
    v_add_u32 v14, 0, v12
    v_add_u32 v15, 0, v13
    ds_read_b64_tr_b16 v[192:193], v14 offset:0
    ds_read_b64_tr_b16 v[194:195], v14 offset:512
    ds_read_b64_tr_b16 v[196:197], v15 offset:0
    ds_read_b64_tr_b16 v[198:199], v15 offset:512
    v_mfma_f32_32x32x16_bf16 v[176:191], v[204:207], v[88:91], v[176:191]
    s_waitcnt lgkmcnt(4)
    v_mfma_f32_32x32x16_bf16 v[160:175], v[208:211], v[92:95], v[160:175]
    ds_read_b64_tr_b16 v[200:201], v14 offset:4096
    ds_read_b64_tr_b16 v[202:203], v14 offset:4608
    ds_read_b64_tr_b16 v[204:205], v15 offset:4096
    ds_read_b64_tr_b16 v[206:207], v15 offset:4608
    v_mfma_f32_32x32x16_bf16 v[176:191], v[212:215], v[92:95], v[176:191]
    s_waitcnt vmcnt(6)
    s_barrier
    s_waitcnt lgkmcnt(4)
    v_mfma_f32_32x32x16_bf16 v[160:175], v[192:195], v[96:99], v[160:175]
    ds_read_b64_tr_b16 v[208:209], v14 offset:8192
    ds_read_b64_tr_b16 v[210:211], v14 offset:8704
    ds_read_b64_tr_b16 v[212:213], v15 offset:8192
    ds_read_b64_tr_b16 v[214:215], v15 offset:8704
    s_add_u32 m0, s83, 81920
    s_add_u32 s36, s77, 128
    buffer_load_dwordx4 v9, s[16:19], s36 offen lds
    v_mfma_f32_32x32x16_bf16 v[176:191], v[196:199], v[96:99], v[176:191]
    s_waitcnt lgkmcnt(4)
    v_mfma_f32_32x32x16_bf16 v[160:175], v[200:203], v[100:103], v[160:175]
    ds_read_b64_tr_b16 v[192:193], v14 offset:12288
    ds_read_b64_tr_b16 v[194:195], v14 offset:12800
    ds_read_b64_tr_b16 v[196:197], v15 offset:12288
    ds_read_b64_tr_b16 v[198:199], v15 offset:12800
    s_add_u32 m0, s83, 90112
    s_add_u32 s36, s77, 114816
    buffer_load_dwordx4 v9, s[16:19], s36 offen lds
    v_mfma_f32_32x32x16_bf16 v[176:191], v[204:207], v[100:103], v[176:191]
    s_waitcnt lgkmcnt(4)
    v_mfma_f32_32x32x16_bf16 v[160:175], v[208:211], v[104:107], v[160:175]
    v_add_u32 v14, 16384, v12
    v_add_u32 v15, 16384, v13
    ds_read_b64_tr_b16 v[200:201], v14 offset:0
    ds_read_b64_tr_b16 v[202:203], v14 offset:512
    ds_read_b64_tr_b16 v[204:205], v15 offset:0
    ds_read_b64_tr_b16 v[206:207], v15 offset:512
    v_mfma_f32_32x32x16_bf16 v[176:191], v[212:215], v[104:107], v[176:191]
    s_waitcnt lgkmcnt(4)
    v_mfma_f32_32x32x16_bf16 v[160:175], v[192:195], v[108:111], v[160:175]
    ds_read_b64_tr_b16 v[208:209], v14 offset:4096
    ds_read_b64_tr_b16 v[210:211], v14 offset:4608
    ds_read_b64_tr_b16 v[212:213], v15 offset:4096
    ds_read_b64_tr_b16 v[214:215], v15 offset:4608
    v_mfma_f32_32x32x16_bf16 v[176:191], v[196:199], v[108:111], v[176:191]
    s_waitcnt vmcnt(6)
    s_waitcnt vmcnt(6)
    s_barrier
    s_cmp_eq_u32 s26, 0
    s_cbranch_scc0 L_parallel_sum__softmax_full_mha__glu_gated_swiglu__prompt_kernel_setq
    v_cmp_gt_u32 vcc, 1, v2
    s_cbranch_vccz L_parallel_sum__softmax_full_mha__glu_gated_swiglu__prompt_kernel_clrok
    v_mov_b32 v1, 0
    s_mov_b32 s91, 200000
L_parallel_sum__softmax_full_mha__glu_gated_swiglu__prompt_kernel_clrq:
    global_load_dword v2, v1, s[24:25] sc1
    s_waitcnt vmcnt(0)
    v_cmp_gt_u32 vcc, 1, v2
    s_cbranch_vccz L_parallel_sum__softmax_full_mha__glu_gated_swiglu__prompt_kernel_clrq_ok
    s_sub_u32 s91, s91, 1
    s_cbranch_scc1 L_parallel_sum__softmax_full_mha__glu_gated_swiglu__prompt_kernel_clrq_ok
    s_sleep 8
    s_branch L_parallel_sum__softmax_full_mha__glu_gated_swiglu__prompt_kernel_clrq
L_parallel_sum__softmax_full_mha__glu_gated_swiglu__prompt_kernel_clrq_ok:
L_parallel_sum__softmax_full_mha__glu_gated_swiglu__prompt_kernel_clrok:
    s_mov_b64 exec, 1
    s_mul_i32 s37, s29, 14
    s_add_u32 s37, s37, s30
    s_lshl_b32 s37, s37, 2
    s_add_u32 s37, s37, 0x1200000
    v_mov_b32 v238, 0
    v_mov_b32 v239, 1
    buffer_store_dword v239, v238, s[4:7], s37 offen sc1
    s_mov_b64 exec, -1
L_parallel_sum__softmax_full_mha__glu_gated_swiglu__prompt_kernel_setq:
    s_waitcnt lgkmcnt(4)
    v_mfma_f32_32x32x16_bf16 v[160:175], v[200:203], v[112:115], v[160:175]
    ds_read_b64_tr_b16 v[192:193], v14 offset:8192
    ds_read_b64_tr_b16 v[194:195], v14 offset:8704
    ds_read_b64_tr_b16 v[196:197], v15 offset:8192
    ds_read_b64_tr_b16 v[198:199], v15 offset:8704
    s_add_u32 m0, s83, 98304
    s_add_u32 s36, s78, 128
    buffer_load_dwordx4 v9, s[16:19], s36 offen lds
    v_mfma_f32_32x32x16_bf16 v[176:191], v[204:207], v[112:115], v[176:191]
    s_waitcnt lgkmcnt(4)
    v_mfma_f32_32x32x16_bf16 v[160:175], v[208:211], v[116:119], v[160:175]
    ds_read_b64_tr_b16 v[200:201], v14 offset:12288
    ds_read_b64_tr_b16 v[202:203], v14 offset:12800
    ds_read_b64_tr_b16 v[204:205], v15 offset:12288
    ds_read_b64_tr_b16 v[206:207], v15 offset:12800
    s_add_u32 m0, s83, 106496
    s_add_u32 s36, s78, 114816
    buffer_load_dwordx4 v9, s[16:19], s36 offen lds
    v_mfma_f32_32x32x16_bf16 v[176:191], v[212:215], v[116:119], v[176:191]
    s_waitcnt lgkmcnt(4)
    v_mfma_f32_32x32x16_bf16 v[160:175], v[192:195], v[120:123], v[160:175]
    v_add_u32 v14, 32768, v12
    v_add_u32 v15, 32768, v13
    ds_read_b64_tr_b16 v[208:209], v14 offset:0
    ds_read_b64_tr_b16 v[210:211], v14 offset:512
    ds_read_b64_tr_b16 v[212:213], v15 offset:0
    ds_read_b64_tr_b16 v[214:215], v15 offset:512
    v_mfma_f32_32x32x16_bf16 v[176:191], v[196:199], v[120:123], v[176:191]
    s_waitcnt lgkmcnt(4)
    v_mfma_f32_32x32x16_bf16 v[160:175], v[200:203], v[124:127], v[160:175]
    ds_read_b64_tr_b16 v[192:193], v14 offset:4096
    ds_read_b64_tr_b16 v[194:195], v14 offset:4608
    ds_read_b64_tr_b16 v[196:197], v15 offset:4096
    ds_read_b64_tr_b16 v[198:199], v15 offset:4608
    v_mfma_f32_32x32x16_bf16 v[176:191], v[204:207], v[124:127], v[176:191]
    s_waitcnt vmcnt(6)
    s_barrier
    s_waitcnt lgkmcnt(4)
    v_mfma_f32_32x32x16_bf16 v[128:143], v[208:211], v[16:19], 0
    ds_read_b64_tr_b16 v[200:201], v14 offset:8192
    ds_read_b64_tr_b16 v[202:203], v14 offset:8704
    ds_read_b64_tr_b16 v[204:205], v15 offset:8192
    ds_read_b64_tr_b16 v[206:207], v15 offset:8704
    s_add_u32 m0, s83, 114688
    s_add_u32 s36, s79, 128
    buffer_load_dwordx4 v9, s[16:19], s36 offen lds
    v_mfma_f32_32x32x16_bf16 v[144:159], v[212:215], v[16:19], 0
    s_waitcnt lgkmcnt(4)
    v_mfma_f32_32x32x16_bf16 v[128:143], v[192:195], v[20:23], v[128:143]
    ds_read_b64_tr_b16 v[208:209], v14 offset:12288
    ds_read_b64_tr_b16 v[210:211], v14 offset:12800
    ds_read_b64_tr_b16 v[212:213], v15 offset:12288
    ds_read_b64_tr_b16 v[214:215], v15 offset:12800
    s_add_u32 m0, s83, 122880
    s_add_u32 s36, s79, 114816
    buffer_load_dwordx4 v9, s[16:19], s36 offen lds
    v_mfma_f32_32x32x16_bf16 v[144:159], v[196:199], v[20:23], v[144:159]
    s_waitcnt lgkmcnt(4)
    v_mfma_f32_32x32x16_bf16 v[128:143], v[200:203], v[24:27], v[128:143]
    v_add_u32 v14, 49152, v12
    v_add_u32 v15, 49152, v13
    ds_read_b64_tr_b16 v[192:193], v14 offset:0
    ds_read_b64_tr_b16 v[194:195], v14 offset:512
    ds_read_b64_tr_b16 v[196:197], v15 offset:0
    ds_read_b64_tr_b16 v[198:199], v15 offset:512
    v_mul_f32 v216, v241, v160
    v_mul_f32 v217, v241, v161
    v_mul_f32 v218, v241, v162
    v_mul_f32 v219, v241, v163
    v_mul_f32 v220, v241, v164
    v_mul_f32 v221, v241, v165
    v_mul_f32 v222, v241, v166
    v_mul_f32 v223, v241, v167
    v_mfma_f32_32x32x16_bf16 v[144:159], v[204:207], v[24:27], v[144:159]
    s_waitcnt lgkmcnt(4)
    v_mfma_f32_32x32x16_bf16 v[128:143], v[208:211], v[28:31], v[128:143]
    ds_read_b64_tr_b16 v[200:201], v14 offset:4096
    ds_read_b64_tr_b16 v[202:203], v14 offset:4608
    ds_read_b64_tr_b16 v[204:205], v15 offset:4096
    ds_read_b64_tr_b16 v[206:207], v15 offset:4608
    v_exp_f32 v216, v216
    v_exp_f32 v217, v217
    v_exp_f32 v218, v218
    v_exp_f32 v219, v219
    v_exp_f32 v220, v220
    v_exp_f32 v221, v221
    v_exp_f32 v222, v222
    v_exp_f32 v223, v223
    v_mfma_f32_32x32x16_bf16 v[144:159], v[212:215], v[28:31], v[144:159]
    s_waitcnt vmcnt(6)
    s_barrier
    s_waitcnt lgkmcnt(4)
    v_mfma_f32_32x32x16_bf16 v[128:143], v[192:195], v[32:35], v[128:143]
    ds_read_b64_tr_b16 v[208:209], v14 offset:8192
    ds_read_b64_tr_b16 v[210:211], v14 offset:8704
    ds_read_b64_tr_b16 v[212:213], v15 offset:8192
    ds_read_b64_tr_b16 v[214:215], v15 offset:8704
    s_add_u32 m0, s83, 131072
    s_add_u32 s36, s80, 128
    buffer_load_dwordx4 v9, s[16:19], s36 offen lds
    v_mul_f32 v224, v160, v168
    v_mul_f32 v225, v161, v169
    v_mul_f32 v226, v162, v170
    v_mul_f32 v227, v163, v171
    v_mul_f32 v228, v164, v172
    v_mul_f32 v229, v165, v173
    v_mul_f32 v230, v166, v174
    v_mul_f32 v231, v167, v175
    v_mfma_f32_32x32x16_bf16 v[144:159], v[196:199], v[32:35], v[144:159]
    s_waitcnt lgkmcnt(4)
    v_mfma_f32_32x32x16_bf16 v[128:143], v[200:203], v[36:39], v[128:143]
    ds_read_b64_tr_b16 v[192:193], v14 offset:12288
    ds_read_b64_tr_b16 v[194:195], v14 offset:12800
    ds_read_b64_tr_b16 v[196:197], v15 offset:12288
    ds_read_b64_tr_b16 v[198:199], v15 offset:12800
    s_add_u32 m0, s83, 139264
    s_add_u32 s36, s80, 114816
    buffer_load_dwordx4 v9, s[16:19], s36 offen lds
    v_add_f32 v216, 1.0, v216
    v_add_f32 v217, 1.0, v217
    v_add_f32 v218, 1.0, v218
    v_add_f32 v219, 1.0, v219
    v_add_f32 v220, 1.0, v220
    v_add_f32 v221, 1.0, v221
    v_add_f32 v222, 1.0, v222
    v_add_f32 v223, 1.0, v223
    v_mfma_f32_32x32x16_bf16 v[144:159], v[204:207], v[36:39], v[144:159]
    s_waitcnt lgkmcnt(4)
    v_mfma_f32_32x32x16_bf16 v[128:143], v[208:211], v[40:43], v[128:143]
    v_add_u32 v14, 65536, v12
    v_add_u32 v15, 65536, v13
    ds_read_b64_tr_b16 v[200:201], v14 offset:0
    ds_read_b64_tr_b16 v[202:203], v14 offset:512
    ds_read_b64_tr_b16 v[204:205], v15 offset:0
    ds_read_b64_tr_b16 v[206:207], v15 offset:512
    v_rcp_f32 v216, v216
    v_rcp_f32 v217, v217
    v_rcp_f32 v218, v218
    v_rcp_f32 v219, v219
    v_rcp_f32 v220, v220
    v_rcp_f32 v221, v221
    v_rcp_f32 v222, v222
    v_rcp_f32 v223, v223
    v_mfma_f32_32x32x16_bf16 v[144:159], v[212:215], v[40:43], v[144:159]
    s_waitcnt lgkmcnt(4)
    v_mfma_f32_32x32x16_bf16 v[128:143], v[192:195], v[44:47], v[128:143]
    ds_read_b64_tr_b16 v[208:209], v14 offset:4096
    ds_read_b64_tr_b16 v[210:211], v14 offset:4608
    ds_read_b64_tr_b16 v[212:213], v15 offset:4096
    ds_read_b64_tr_b16 v[214:215], v15 offset:4608
    v_mul_f32 v224, v242, v224
    v_mul_f32 v225, v242, v225
    v_mul_f32 v226, v242, v226
    v_mul_f32 v227, v242, v227
    v_mul_f32 v228, v242, v228
    v_mul_f32 v229, v242, v229
    v_mul_f32 v230, v242, v230
    v_mul_f32 v231, v242, v231
    v_mfma_f32_32x32x16_bf16 v[144:159], v[196:199], v[44:47], v[144:159]
    s_waitcnt vmcnt(6)
    s_barrier
    s_waitcnt lgkmcnt(4)
    v_mfma_f32_32x32x16_bf16 v[128:143], v[200:203], v[48:51], v[128:143]
    ds_read_b64_tr_b16 v[192:193], v14 offset:8192
    ds_read_b64_tr_b16 v[194:195], v14 offset:8704
    ds_read_b64_tr_b16 v[196:197], v15 offset:8192
    ds_read_b64_tr_b16 v[198:199], v15 offset:8704
    v_mul_f32 v224, v224, v216
    v_mul_f32 v225, v225, v217
    v_mul_f32 v226, v226, v218
    v_mul_f32 v227, v227, v219
    v_mul_f32 v228, v228, v220
    v_mul_f32 v229, v229, v221
    v_mul_f32 v230, v230, v222
    v_mul_f32 v231, v231, v223
    v_mfma_f32_32x32x16_bf16 v[144:159], v[204:207], v[48:51], v[144:159]
    s_waitcnt lgkmcnt(4)
    v_mfma_f32_32x32x16_bf16 v[128:143], v[208:211], v[52:55], v[128:143]
    ds_read_b64_tr_b16 v[200:201], v14 offset:12288
    ds_read_b64_tr_b16 v[202:203], v14 offset:12800
    ds_read_b64_tr_b16 v[204:205], v15 offset:12288
    ds_read_b64_tr_b16 v[206:207], v15 offset:12800
    v_cvt_pk_bf16_f32 v232, v224, v225
    v_cvt_pk_bf16_f32 v233, v226, v227
    v_cvt_pk_bf16_f32 v234, v228, v229
    v_cvt_pk_bf16_f32 v235, v230, v231
    s_add_u32 s84, s86, 0
    buffer_store_dwordx4 v[232:235], v243, s[4:7], s84 offen sc1
    v_mul_f32 v216, v241, v176
    v_mul_f32 v217, v241, v177
    v_mfma_f32_32x32x16_bf16 v[144:159], v[212:215], v[52:55], v[144:159]
    s_waitcnt lgkmcnt(4)
    v_mfma_f32_32x32x16_bf16 v[128:143], v[192:195], v[56:59], v[128:143]
    v_add_u32 v14, 81920, v12
    v_add_u32 v15, 81920, v13
    ds_read_b64_tr_b16 v[208:209], v14 offset:0
    ds_read_b64_tr_b16 v[210:211], v14 offset:512
    ds_read_b64_tr_b16 v[212:213], v15 offset:0
    ds_read_b64_tr_b16 v[214:215], v15 offset:512
    v_mul_f32 v218, v241, v178
    v_mul_f32 v219, v241, v179
    v_mul_f32 v220, v241, v180
    v_mul_f32 v221, v241, v181
    v_mul_f32 v222, v241, v182
    v_mul_f32 v223, v241, v183
    v_exp_f32 v216, v216
    v_exp_f32 v217, v217
    v_mfma_f32_32x32x16_bf16 v[144:159], v[196:199], v[56:59], v[144:159]
    s_waitcnt lgkmcnt(4)
    v_mfma_f32_32x32x16_bf16 v[128:143], v[200:203], v[60:63], v[128:143]
    ds_read_b64_tr_b16 v[192:193], v14 offset:4096
    ds_read_b64_tr_b16 v[194:195], v14 offset:4608
    ds_read_b64_tr_b16 v[196:197], v15 offset:4096
    ds_read_b64_tr_b16 v[198:199], v15 offset:4608
    v_exp_f32 v218, v218
    v_exp_f32 v219, v219
    v_exp_f32 v220, v220
    v_exp_f32 v221, v221
    v_exp_f32 v222, v222
    v_exp_f32 v223, v223
    v_mul_f32 v224, v176, v184
    v_mul_f32 v225, v177, v185
    v_mfma_f32_32x32x16_bf16 v[144:159], v[204:207], v[60:63], v[144:159]
    s_waitcnt vmcnt(5)
    s_barrier
    s_waitcnt lgkmcnt(4)
    v_mfma_f32_32x32x16_bf16 v[128:143], v[208:211], v[64:67], v[128:143]
    ds_read_b64_tr_b16 v[200:201], v14 offset:8192
    ds_read_b64_tr_b16 v[202:203], v14 offset:8704
    ds_read_b64_tr_b16 v[204:205], v15 offset:8192
    ds_read_b64_tr_b16 v[206:207], v15 offset:8704
    v_mul_f32 v226, v178, v186
    v_mul_f32 v227, v179, v187
    v_mul_f32 v228, v180, v188
    v_mul_f32 v229, v181, v189
    v_mul_f32 v230, v182, v190
    v_mul_f32 v231, v183, v191
    v_add_f32 v216, 1.0, v216
    v_add_f32 v217, 1.0, v217
    v_mfma_f32_32x32x16_bf16 v[144:159], v[212:215], v[64:67], v[144:159]
    s_waitcnt lgkmcnt(4)
    v_mfma_f32_32x32x16_bf16 v[128:143], v[192:195], v[68:71], v[128:143]
    ds_read_b64_tr_b16 v[208:209], v14 offset:12288
    ds_read_b64_tr_b16 v[210:211], v14 offset:12800
    ds_read_b64_tr_b16 v[212:213], v15 offset:12288
    ds_read_b64_tr_b16 v[214:215], v15 offset:12800
    v_add_f32 v218, 1.0, v218
    v_add_f32 v219, 1.0, v219
    v_add_f32 v220, 1.0, v220
    v_add_f32 v221, 1.0, v221
    v_add_f32 v222, 1.0, v222
    v_add_f32 v223, 1.0, v223
    v_rcp_f32 v216, v216
    v_rcp_f32 v217, v217
    v_mfma_f32_32x32x16_bf16 v[144:159], v[196:199], v[68:71], v[144:159]
    s_waitcnt lgkmcnt(4)
    v_mfma_f32_32x32x16_bf16 v[128:143], v[200:203], v[72:75], v[128:143]
    v_add_u32 v14, 98304, v12
    v_add_u32 v15, 98304, v13
    ds_read_b64_tr_b16 v[192:193], v14 offset:0
    ds_read_b64_tr_b16 v[194:195], v14 offset:512
    ds_read_b64_tr_b16 v[196:197], v15 offset:0
    ds_read_b64_tr_b16 v[198:199], v15 offset:512
    v_rcp_f32 v218, v218
    v_rcp_f32 v219, v219
    v_rcp_f32 v220, v220
    v_rcp_f32 v221, v221
    v_rcp_f32 v222, v222
    v_rcp_f32 v223, v223
    v_mul_f32 v224, v242, v224
    v_mul_f32 v225, v242, v225
    v_mfma_f32_32x32x16_bf16 v[144:159], v[204:207], v[72:75], v[144:159]
    s_waitcnt lgkmcnt(4)
    v_mfma_f32_32x32x16_bf16 v[128:143], v[208:211], v[76:79], v[128:143]
    ds_read_b64_tr_b16 v[200:201], v14 offset:4096
    ds_read_b64_tr_b16 v[202:203], v14 offset:4608
    ds_read_b64_tr_b16 v[204:205], v15 offset:4096
    ds_read_b64_tr_b16 v[206:207], v15 offset:4608
    v_mul_f32 v226, v242, v226
    v_mul_f32 v227, v242, v227
    v_mul_f32 v228, v242, v228
    v_mul_f32 v229, v242, v229
    v_mul_f32 v230, v242, v230
    v_mul_f32 v231, v242, v231
    v_mul_f32 v224, v224, v216
    v_mul_f32 v225, v225, v217
    v_mfma_f32_32x32x16_bf16 v[144:159], v[212:215], v[76:79], v[144:159]
    s_waitcnt vmcnt(3)
    s_barrier
    s_waitcnt lgkmcnt(4)
    v_mfma_f32_32x32x16_bf16 v[128:143], v[192:195], v[80:83], v[128:143]
    ds_read_b64_tr_b16 v[208:209], v14 offset:8192
    ds_read_b64_tr_b16 v[210:211], v14 offset:8704
    ds_read_b64_tr_b16 v[212:213], v15 offset:8192
    ds_read_b64_tr_b16 v[214:215], v15 offset:8704
    v_mul_f32 v226, v226, v218
    v_mul_f32 v227, v227, v219
    v_mul_f32 v228, v228, v220
    v_mul_f32 v229, v229, v221
    v_mul_f32 v230, v230, v222
    v_mul_f32 v231, v231, v223
    v_cvt_pk_bf16_f32 v232, v224, v225
    v_cvt_pk_bf16_f32 v233, v226, v227
    v_mfma_f32_32x32x16_bf16 v[144:159], v[196:199], v[80:83], v[144:159]
    s_waitcnt lgkmcnt(4)
    v_mfma_f32_32x32x16_bf16 v[128:143], v[200:203], v[84:87], v[128:143]
    ds_read_b64_tr_b16 v[192:193], v14 offset:12288
    ds_read_b64_tr_b16 v[194:195], v14 offset:12800
    ds_read_b64_tr_b16 v[196:197], v15 offset:12288
    ds_read_b64_tr_b16 v[198:199], v15 offset:12800
    v_cvt_pk_bf16_f32 v234, v228, v229
    v_cvt_pk_bf16_f32 v235, v230, v231
    s_add_u32 s84, s86, 1024
    buffer_store_dwordx4 v[232:235], v243, s[4:7], s84 offen sc1
    v_mfma_f32_32x32x16_bf16 v[144:159], v[204:207], v[84:87], v[144:159]
    s_waitcnt lgkmcnt(4)
    v_mfma_f32_32x32x16_bf16 v[128:143], v[208:211], v[88:91], v[128:143]
    v_add_u32 v14, 114688, v12
    v_add_u32 v15, 114688, v13
    ds_read_b64_tr_b16 v[200:201], v14 offset:0
    ds_read_b64_tr_b16 v[202:203], v14 offset:512
    ds_read_b64_tr_b16 v[204:205], v15 offset:0
    ds_read_b64_tr_b16 v[206:207], v15 offset:512
    v_mfma_f32_32x32x16_bf16 v[144:159], v[212:215], v[88:91], v[144:159]
    s_waitcnt lgkmcnt(4)
    v_mfma_f32_32x32x16_bf16 v[128:143], v[192:195], v[92:95], v[128:143]
    ds_read_b64_tr_b16 v[208:209], v14 offset:4096
    ds_read_b64_tr_b16 v[210:211], v14 offset:4608
    ds_read_b64_tr_b16 v[212:213], v15 offset:4096
    ds_read_b64_tr_b16 v[214:215], v15 offset:4608
    v_mfma_f32_32x32x16_bf16 v[144:159], v[196:199], v[92:95], v[144:159]
    s_waitcnt vmcnt(2)
    s_barrier
    s_cmp_eq_u32 s33, 0
    s_cbranch_scc0 L_parallel_sum__softmax_full_mha__glu_gated_swiglu__prompt_kernel_e76
    v_lshlrev_b32 v1, 4, v0
    s_mov_b32 s39, 0x1200000
    buffer_load_dwordx4 v[224:227], v1, s[4:7], s39 offen sc1
L_parallel_sum__softmax_full_mha__glu_gated_swiglu__prompt_kernel_e76:
    s_waitcnt lgkmcnt(4)
    v_mfma_f32_32x32x16_bf16 v[128:143], v[200:203], v[96:99], v[128:143]
    ds_read_b64_tr_b16 v[192:193], v14 offset:8192
    ds_read_b64_tr_b16 v[194:195], v14 offset:8704
    ds_read_b64_tr_b16 v[196:197], v15 offset:8192
    ds_read_b64_tr_b16 v[198:199], v15 offset:8704
    v_mfma_f32_32x32x16_bf16 v[144:159], v[204:207], v[96:99], v[144:159]
    s_waitcnt lgkmcnt(4)
    v_mfma_f32_32x32x16_bf16 v[128:143], v[208:211], v[100:103], v[128:143]
    ds_read_b64_tr_b16 v[200:201], v14 offset:12288
    ds_read_b64_tr_b16 v[202:203], v14 offset:12800
    ds_read_b64_tr_b16 v[204:205], v15 offset:12288
    ds_read_b64_tr_b16 v[206:207], v15 offset:12800
    v_mfma_f32_32x32x16_bf16 v[144:159], v[212:215], v[100:103], v[144:159]
    s_waitcnt lgkmcnt(4)
    v_mfma_f32_32x32x16_bf16 v[128:143], v[192:195], v[104:107], v[128:143]
    v_add_u32 v14, 131072, v12
    v_add_u32 v15, 131072, v13
    ds_read_b64_tr_b16 v[208:209], v14 offset:0
    ds_read_b64_tr_b16 v[210:211], v14 offset:512
    ds_read_b64_tr_b16 v[212:213], v15 offset:0
    ds_read_b64_tr_b16 v[214:215], v15 offset:512
    v_mfma_f32_32x32x16_bf16 v[144:159], v[196:199], v[104:107], v[144:159]
    s_waitcnt lgkmcnt(4)
    v_mfma_f32_32x32x16_bf16 v[128:143], v[200:203], v[108:111], v[128:143]
    ds_read_b64_tr_b16 v[192:193], v14 offset:4096
    ds_read_b64_tr_b16 v[194:195], v14 offset:4608
    ds_read_b64_tr_b16 v[196:197], v15 offset:4096
    ds_read_b64_tr_b16 v[198:199], v15 offset:4608
    v_mfma_f32_32x32x16_bf16 v[144:159], v[204:207], v[108:111], v[144:159]
    s_barrier
    s_waitcnt lgkmcnt(4)
    v_mfma_f32_32x32x16_bf16 v[128:143], v[208:211], v[112:115], v[128:143]
    ds_read_b64_tr_b16 v[200:201], v14 offset:8192
    ds_read_b64_tr_b16 v[202:203], v14 offset:8704
    ds_read_b64_tr_b16 v[204:205], v15 offset:8192
    ds_read_b64_tr_b16 v[206:207], v15 offset:8704
    v_mfma_f32_32x32x16_bf16 v[144:159], v[212:215], v[112:115], v[144:159]
    s_waitcnt lgkmcnt(4)
    v_mfma_f32_32x32x16_bf16 v[128:143], v[192:195], v[116:119], v[128:143]
    ds_read_b64_tr_b16 v[208:209], v14 offset:12288
    ds_read_b64_tr_b16 v[210:211], v14 offset:12800
    ds_read_b64_tr_b16 v[212:213], v15 offset:12288
    ds_read_b64_tr_b16 v[214:215], v15 offset:12800
    v_mfma_f32_32x32x16_bf16 v[144:159], v[196:199], v[116:119], v[144:159]
    s_waitcnt lgkmcnt(4)
    v_mfma_f32_32x32x16_bf16 v[128:143], v[200:203], v[120:123], v[128:143]
    v_mfma_f32_32x32x16_bf16 v[144:159], v[204:207], v[120:123], v[144:159]
    s_waitcnt lgkmcnt(0)
    v_mfma_f32_32x32x16_bf16 v[128:143], v[208:211], v[124:127], v[128:143]
    v_mfma_f32_32x32x16_bf16 v[144:159], v[212:215], v[124:127], v[144:159]
    s_waitcnt vmcnt(0)
    s_barrier
    s_cmp_eq_u32 s26, 7
    s_cbranch_scc0 L_parallel_sum__softmax_full_mha__glu_gated_swiglu__prompt_kernel_seth0
    s_mov_b64 exec, 1
    s_mul_i32 s37, s29, 16
    s_add_u32 s37, s37, s30
    s_lshl_b32 s37, s37, 2
    s_add_u32 s37, s37, 0x1201800
    v_mov_b32 v238, 0
    v_mov_b32 v239, 1
    buffer_store_dword v239, v238, s[4:7], s37 offen sc1
    s_mov_b64 exec, -1
L_parallel_sum__softmax_full_mha__glu_gated_swiglu__prompt_kernel_seth0:
    s_cmp_ge_u32 s26, 4
    s_cbranch_scc1 L_parallel_sum__softmax_full_mha__glu_gated_swiglu__prompt_kernel_gemm_a
    s_waitcnt vmcnt(0)
    v_and_b32 v228, v224, v225
    v_and_b32 v229, v226, v227
    v_and_b32 v228, v228, v229
    s_mov_b32 exec_hi, 0x00ffffff
    v_cmp_ne_u32 vcc, 1, v228
    s_mov_b64 exec, -1
    s_cbranch_vccz L_parallel_sum__softmax_full_mha__glu_gated_swiglu__prompt_kernel_qok
    v_mov_b32 v208, 0
    s_mov_b32 s91, 200000
L_parallel_sum__softmax_full_mha__glu_gated_swiglu__prompt_kernel_aclr:
    global_load_dword v209, v208, s[24:25] sc1
    s_waitcnt vmcnt(0)
    v_cmp_gt_u32 vcc, 1, v209
    s_cbranch_vccz L_parallel_sum__softmax_full_mha__glu_gated_swiglu__prompt_kernel_aclr_ok
    s_sub_u32 s91, s91, 1
    s_cbranch_scc1 L_parallel_sum__softmax_full_mha__glu_gated_swiglu__prompt_kernel_aclr_ok
    s_sleep 8
    s_branch L_parallel_sum__softmax_full_mha__glu_gated_swiglu__prompt_kernel_aclr
L_parallel_sum__softmax_full_mha__glu_gated_swiglu__prompt_kernel_aclr_ok:
    v_lshlrev_b32 v212, 4, v0
    s_mov_b32 s39, 0x1200000
    s_mov_b32 exec_lo, -1
    s_mov_b32 exec_hi, 0x00ffffff
    s_mov_b32 s91, 200000
L_parallel_sum__softmax_full_mha__glu_gated_swiglu__prompt_kernel_aq:
    buffer_load_dwordx4 v[208:211], v212, s[4:7], s39 offen sc1
    s_waitcnt vmcnt(0)
    v_and_b32 v208, v208, v209
    v_and_b32 v210, v210, v211
    v_and_b32 v208, v208, v210
    v_cmp_ne_u32 vcc, 1, v208
    s_cbranch_vccz L_parallel_sum__softmax_full_mha__glu_gated_swiglu__prompt_kernel_aq_ok
    s_sub_u32 s91, s91, 1
    s_cbranch_scc1 L_parallel_sum__softmax_full_mha__glu_gated_swiglu__prompt_kernel_aq_ok
    s_sleep 8
    s_branch L_parallel_sum__softmax_full_mha__glu_gated_swiglu__prompt_kernel_aq
L_parallel_sum__softmax_full_mha__glu_gated_swiglu__prompt_kernel_aq_ok:
    s_mov_b64 exec, -1
L_parallel_sum__softmax_full_mha__glu_gated_swiglu__prompt_kernel_qok:
    s_and_b32 s37, s28, 1
    s_lshl_b32 s60, s27, 1
    s_add_u32 s60, s60, s37
    s_lshr_b32 s61, s28, 1
    s_mul_i32 s62, s27, 7
    s_mul_i32 s38, s37, 3
    s_add_u32 s62, s62, s38
    v_lshlrev_b32 v1, 4, v0
    s_mov_b32 s92, 0x0fffffff
    s_mov_b32 s93, 0x0fffffff
    s_lshl_b32 s36, s61, 2
    s_mul_i32 s36, s36, 28672
    s_lshl_b32 s37, s62, 9
    s_add_u32 s36, s36, s37
    s_add_u32 s38, s36, 0x700000
    s_add_u32 s36, s26, 0
    s_and_b32 s36, s36, 3
    s_mul_i32 s36, s36, 28672
    s_add_u32 s80, s36, s38
    s_add_u32 s36, s26, 1
    s_and_b32 s36, s36, 3
    s_mul_i32 s36, s36, 28672
    s_add_u32 s81, s36, s38
    s_add_u32 s36, s26, 2
    s_and_b32 s36, s36, 3
    s_mul_i32 s36, s36, 28672
    s_add_u32 s82, s36, s38
    s_add_u32 s36, s26, 3
    s_and_b32 s36, s36, 3
    s_mul_i32 s36, s36, 28672
    s_add_u32 s87, s36, s38
    buffer_load_dwordx4 v[16:19], v1, s[4:7], s80 offen offset:0 sc1
    buffer_load_dwordx4 v[20:23], v1, s[4:7], s80 offen offset:1024 sc1
    s_mul_i32 s65, s26, 458752
    s_add_u32 s66, s65, 458752
    s_and_b32 s36, s61, 3
    s_mul_i32 s36, s36, 114688
    s_add_u32 s76, s36, s65
    s_add_u32 s77, s76, 28672
    s_add_u32 s78, s76, 57344
    s_add_u32 s79, s76, 86016
    s_lshl_b32 s37, s62, 9
    s_add_u32 s37, s37, 0x8c0000
    v_add_u32 v8, s37, v1
    buffer_load_dwordx4 v[48:51], v8, s[4:7], s76 offen offset:0 sc1
    buffer_load_dwordx4 v[52:55], v8, s[4:7], s76 offen offset:1024 sc1
    v_and_b32 v4, 31, v0
    v_lshrrev_b32 v5, 5, v0
    s_mul_i32 s37, s60, 28
    v_add_u32 v6, s37, v4
    v_lshlrev_b32 v6, 4, v6
    v_mul_u32_u24 v7, 7168, v5
    v_add_u32 v2, v6, v7
    v_add_u32 v2, 0xa80000, v2
    v_add_u32 v3, 14336, v2
    v_cmp_eq_u32 vcc, 28, v4
    v_mov_b32 v9, 0x3f803f80
    s_nop 0
    v_cndmask_b32 v9, 0, v9, vcc
    v_mov_b32 v64, v9
    v_mov_b32 v65, v9
    v_mov_b32 v66, v9
    v_mov_b32 v67, v9
    v_mov_b32 v68, v9
    v_mov_b32 v69, v9
    v_mov_b32 v70, v9
    v_mov_b32 v71, v9
    v_mov_b32 v72, v9
    v_mov_b32 v73, v9
    v_mov_b32 v74, v9
    v_mov_b32 v75, v9
    v_mov_b32 v76, v9
    v_mov_b32 v77, v9
    v_mov_b32 v78, v9
    v_mov_b32 v79, v9
    s_mov_b64 exec, s[92:93]
    buffer_load_dwordx4 v[64:67], v2, s[4:7], s76 offen sc1
    buffer_load_dwordx4 v[68:71], v3, s[4:7], s76 offen sc1
    s_mov_b64 exec, -1
    v_mul_f32 v216, v241, v128
    v_mul_f32 v217, v241, v129
    v_mul_f32 v218, v241, v130
    v_mul_f32 v219, v241, v131
    v_mul_f32 v220, v241, v132
    v_mul_f32 v221, v241, v133
    v_mul_f32 v222, v241, v134
    v_mul_f32 v223, v241, v135
    buffer_load_dwordx4 v[24:27], v1, s[4:7], s81 offen offset:0 sc1
    v_exp_f32 v216, v216
    v_exp_f32 v217, v217
    v_exp_f32 v218, v218
    v_exp_f32 v219, v219
    v_exp_f32 v220, v220
    v_exp_f32 v221, v221
    v_exp_f32 v222, v222
    v_exp_f32 v223, v223
    buffer_load_dwordx4 v[28:31], v1, s[4:7], s81 offen offset:1024 sc1
    v_mul_f32 v224, v128, v136
    v_mul_f32 v225, v129, v137
    v_mul_f32 v226, v130, v138
    v_mul_f32 v227, v131, v139
    v_mul_f32 v228, v132, v140
    v_mul_f32 v229, v133, v141
    v_mul_f32 v230, v134, v142
    v_mul_f32 v231, v135, v143
    buffer_load_dwordx4 v[32:35], v1, s[4:7], s82 offen offset:0 sc1
    v_add_f32 v216, 1.0, v216
    v_add_f32 v217, 1.0, v217
    v_add_f32 v218, 1.0, v218
    v_add_f32 v219, 1.0, v219
    v_add_f32 v220, 1.0, v220
    v_add_f32 v221, 1.0, v221
    v_add_f32 v222, 1.0, v222
    v_add_f32 v223, 1.0, v223
    buffer_load_dwordx4 v[36:39], v1, s[4:7], s82 offen offset:1024 sc1
    v_rcp_f32 v216, v216
    v_rcp_f32 v217, v217
    v_rcp_f32 v218, v218
    v_rcp_f32 v219, v219
    v_rcp_f32 v220, v220
    v_rcp_f32 v221, v221
    v_rcp_f32 v222, v222
    v_rcp_f32 v223, v223
    buffer_load_dwordx4 v[40:43], v1, s[4:7], s87 offen offset:0 sc1
    v_mul_f32 v224, v242, v224
    v_mul_f32 v225, v242, v225
    v_mul_f32 v226, v242, v226
    v_mul_f32 v227, v242, v227
    v_mul_f32 v228, v242, v228
    v_mul_f32 v229, v242, v229
    v_mul_f32 v230, v242, v230
    v_mul_f32 v231, v242, v231
    buffer_load_dwordx4 v[44:47], v1, s[4:7], s87 offen offset:1024 sc1
    v_mul_f32 v224, v224, v216
    v_mul_f32 v225, v225, v217
    v_mul_f32 v226, v226, v218
    v_mul_f32 v227, v227, v219
    v_mul_f32 v228, v228, v220
    v_mul_f32 v229, v229, v221
    v_mul_f32 v230, v230, v222
    v_mul_f32 v231, v231, v223
    v_cvt_pk_bf16_f32 v232, v224, v225
    v_cvt_pk_bf16_f32 v233, v226, v227
    v_cvt_pk_bf16_f32 v234, v228, v229
    v_cvt_pk_bf16_f32 v235, v230, v231
    s_add_u32 s84, s86, 4096
    buffer_store_dwordx4 v[232:235], v243, s[4:7], s84 offen sc1
    v_mul_f32 v216, v241, v144
    v_mul_f32 v217, v241, v145
    v_mul_f32 v218, v241, v146
    v_mul_f32 v219, v241, v147
    v_mul_f32 v220, v241, v148
    v_mul_f32 v221, v241, v149
    v_mul_f32 v222, v241, v150
    v_mul_f32 v223, v241, v151
    v_exp_f32 v216, v216
    v_exp_f32 v217, v217
    v_exp_f32 v218, v218
    v_exp_f32 v219, v219
    v_exp_f32 v220, v220
    v_exp_f32 v221, v221
    v_exp_f32 v222, v222
    v_exp_f32 v223, v223
    v_mul_f32 v224, v144, v152
    v_mul_f32 v225, v145, v153
    v_mul_f32 v226, v146, v154
    v_mul_f32 v227, v147, v155
    buffer_load_dwordx4 v[56:59], v8, s[4:7], s77 offen offset:0 sc1
    buffer_load_dwordx4 v[60:63], v8, s[4:7], s77 offen offset:1024 sc1
    v_mul_f32 v228, v148, v156
    v_mul_f32 v229, v149, v157
    v_mul_f32 v230, v150, v158
    v_mul_f32 v231, v151, v159
    v_add_f32 v216, 1.0, v216
    v_add_f32 v217, 1.0, v217
    v_add_f32 v218, 1.0, v218
    v_add_f32 v219, 1.0, v219
    v_add_f32 v220, 1.0, v220
    v_add_f32 v221, 1.0, v221
    v_add_f32 v222, 1.0, v222
    v_add_f32 v223, 1.0, v223
    v_rcp_f32 v216, v216
    v_rcp_f32 v217, v217
    v_rcp_f32 v218, v218
    v_rcp_f32 v219, v219
    v_rcp_f32 v220, v220
    v_rcp_f32 v221, v221
    v_rcp_f32 v222, v222
    v_rcp_f32 v223, v223
    s_mov_b64 exec, s[92:93]
    buffer_load_dwordx4 v[72:75], v2, s[4:7], s77 offen sc1
    buffer_load_dwordx4 v[76:79], v3, s[4:7], s77 offen sc1
    s_mov_b64 exec, -1
    v_mul_f32 v224, v242, v224
    v_mul_f32 v225, v242, v225
    v_mul_f32 v226, v242, v226
    v_mul_f32 v227, v242, v227
    v_mul_f32 v228, v242, v228
    v_mul_f32 v229, v242, v229
    v_mul_f32 v230, v242, v230
    v_mul_f32 v231, v242, v231
    v_mul_f32 v224, v224, v216
    v_mul_f32 v225, v225, v217
    v_mul_f32 v226, v226, v218
    v_mul_f32 v227, v227, v219
    v_mul_f32 v228, v228, v220
    v_mul_f32 v229, v229, v221
    v_mul_f32 v230, v230, v222
    v_mul_f32 v231, v231, v223
    v_cvt_pk_bf16_f32 v232, v224, v225
    v_cvt_pk_bf16_f32 v233, v226, v227
    v_cvt_pk_bf16_f32 v234, v228, v229
    v_cvt_pk_bf16_f32 v235, v230, v231
    s_add_u32 s84, s86, 5120
    buffer_store_dwordx4 v[232:235], v243, s[4:7], s84 offen sc1
    s_mov_b32 s63, 1
    s_branch L_parallel_sum__softmax_full_mha__glu_gated_swiglu__prompt_kernel_attn
L_parallel_sum__softmax_full_mha__glu_gated_swiglu__prompt_kernel_gemm_a:
    s_nop 7
    s_nop 3
    v_mul_f32 v216, v241, v128
    v_mul_f32 v217, v241, v129
    v_mul_f32 v218, v241, v130
    v_mul_f32 v219, v241, v131
    v_mul_f32 v220, v241, v132
    v_mul_f32 v221, v241, v133
    v_mul_f32 v222, v241, v134
    v_mul_f32 v223, v241, v135
    v_exp_f32 v216, v216
    v_exp_f32 v217, v217
    v_exp_f32 v218, v218
    v_exp_f32 v219, v219
    v_exp_f32 v220, v220
    v_exp_f32 v221, v221
    v_exp_f32 v222, v222
    v_exp_f32 v223, v223
    v_mul_f32 v224, v128, v136
    v_mul_f32 v225, v129, v137
    v_mul_f32 v226, v130, v138
    v_mul_f32 v227, v131, v139
    v_mul_f32 v228, v132, v140
    v_mul_f32 v229, v133, v141
    v_mul_f32 v230, v134, v142
    v_mul_f32 v231, v135, v143
    v_add_f32 v216, 1.0, v216
    v_add_f32 v217, 1.0, v217
    v_add_f32 v218, 1.0, v218
    v_add_f32 v219, 1.0, v219
    v_add_f32 v220, 1.0, v220
    v_add_f32 v221, 1.0, v221
    v_add_f32 v222, 1.0, v222
    v_add_f32 v223, 1.0, v223
    v_rcp_f32 v216, v216
    v_rcp_f32 v217, v217
    v_rcp_f32 v218, v218
    v_rcp_f32 v219, v219
    v_rcp_f32 v220, v220
    v_rcp_f32 v221, v221
    v_rcp_f32 v222, v222
    v_rcp_f32 v223, v223
    v_mul_f32 v224, v242, v224
    v_mul_f32 v225, v242, v225
    v_mul_f32 v226, v242, v226
    v_mul_f32 v227, v242, v227
    v_mul_f32 v228, v242, v228
    v_mul_f32 v229, v242, v229
    v_mul_f32 v230, v242, v230
    v_mul_f32 v231, v242, v231
    v_mul_f32 v224, v224, v216
    v_mul_f32 v225, v225, v217
    v_mul_f32 v226, v226, v218
    v_mul_f32 v227, v227, v219
    v_mul_f32 v228, v228, v220
    v_mul_f32 v229, v229, v221
    v_mul_f32 v230, v230, v222
    v_mul_f32 v231, v231, v223
    v_cvt_pk_bf16_f32 v232, v224, v225
    v_cvt_pk_bf16_f32 v233, v226, v227
    v_cvt_pk_bf16_f32 v234, v228, v229
    v_cvt_pk_bf16_f32 v235, v230, v231
    s_add_u32 s84, s86, 4096
    buffer_store_dwordx4 v[232:235], v243, s[4:7], s84 offen sc1
    v_mul_f32 v216, v241, v144
    v_mul_f32 v217, v241, v145
    v_mul_f32 v218, v241, v146
    v_mul_f32 v219, v241, v147
    v_mul_f32 v220, v241, v148
    v_mul_f32 v221, v241, v149
    v_mul_f32 v222, v241, v150
    v_mul_f32 v223, v241, v151
    v_exp_f32 v216, v216
    v_exp_f32 v217, v217
    v_exp_f32 v218, v218
    v_exp_f32 v219, v219
    v_exp_f32 v220, v220
    v_exp_f32 v221, v221
    v_exp_f32 v222, v222
    v_exp_f32 v223, v223
    v_mul_f32 v224, v144, v152
    v_mul_f32 v225, v145, v153
    v_mul_f32 v226, v146, v154
    v_mul_f32 v227, v147, v155
    v_mul_f32 v228, v148, v156
    v_mul_f32 v229, v149, v157
    v_mul_f32 v230, v150, v158
    v_mul_f32 v231, v151, v159
    v_add_f32 v216, 1.0, v216
    v_add_f32 v217, 1.0, v217
    v_add_f32 v218, 1.0, v218
    v_add_f32 v219, 1.0, v219
    v_add_f32 v220, 1.0, v220
    v_add_f32 v221, 1.0, v221
    v_add_f32 v222, 1.0, v222
    v_add_f32 v223, 1.0, v223
    v_rcp_f32 v216, v216
    v_rcp_f32 v217, v217
    v_rcp_f32 v218, v218
    v_rcp_f32 v219, v219
    v_rcp_f32 v220, v220
    v_rcp_f32 v221, v221
    v_rcp_f32 v222, v222
    v_rcp_f32 v223, v223
    v_mul_f32 v224, v242, v224
    v_mul_f32 v225, v242, v225
    v_mul_f32 v226, v242, v226
    v_mul_f32 v227, v242, v227
    v_mul_f32 v228, v242, v228
    v_mul_f32 v229, v242, v229
    v_mul_f32 v230, v242, v230
    v_mul_f32 v231, v242, v231
    v_mul_f32 v224, v224, v216
    v_mul_f32 v225, v225, v217
    v_mul_f32 v226, v226, v218
    v_mul_f32 v227, v227, v219
    v_mul_f32 v228, v228, v220
    v_mul_f32 v229, v229, v221
    v_mul_f32 v230, v230, v222
    v_mul_f32 v231, v231, v223
    v_cvt_pk_bf16_f32 v232, v224, v225
    v_cvt_pk_bf16_f32 v233, v226, v227
    v_cvt_pk_bf16_f32 v234, v228, v229
    v_cvt_pk_bf16_f32 v235, v230, v231
    s_add_u32 s84, s86, 5120
    buffer_store_dwordx4 v[232:235], v243, s[4:7], s84 offen sc1
    s_mov_b32 s12, s52
    s_and_b32 s13, s53, 0xffff
    s_mov_b32 s14, 1605632
    s_mov_b32 s15, 0x20000
    s_mov_b32 s16, s44
    s_and_b32 s17, s45, 0xffff
    s_mov_b32 s18, 401408
    s_mov_b32 s19, 0x20000
    s_mov_b32 s20, s54
    s_and_b32 s21, s55, 0xffff
    s_mov_b32 s22, 1835008
    s_mov_b32 s23, 0x20000
    s_sub_u32 s73, s26, 4
    s_lshl_b32 s65, s27, 2
    s_and_b32 s37, s28, 3
    s_add_u32 s65, s65, s37
    s_lshr_b32 s66, s28, 2
    s_lshl_b32 s37, s37, 1
    s_add_u32 s37, s37, s66
    s_cmp_ge_u32 s37, 7
    s_cselect_b32 s38, 7, 0
    s_sub_u32 s37, s37, s38
    s_lshl_b32 s72, s37, 1
    v_lshlrev_b32 v1, 4, v0
    v_lshrrev_b32 v192, 3, v0
    v_and_b32 v193, 7, v0
    v_bfe_u32 v194, v0, 4, 1
    v_lshlrev_b32 v194, 2, v194
    v_xor_b32 v193, v193, v194
    v_lshlrev_b32 v193, 4, v193
    v_mul_u32_u24 v192, 896, v192
    v_add_u32 v2, v192, v193
    s_mul_i32 s83, s73, 24576
    s_add_u32 s83, s83, 61440
    s_lshl_b32 s69, s66, 7
    s_mul_i32 s37, s73, 14336
    s_add_u32 s69, s69, s37
    s_lshl_b32 s36, s65, 1
    s_mul_i32 s67, s36, 114688
    s_lshr_b32 s37, s73, 1
    s_mul_i32 s38, s37, 114688
    s_add_u32 s67, s67, s38
    s_lshl_b32 s38, s73, 10
    s_mul_i32 s38, s38, 1
    s_add_u32 s67, s67, s38
    s_cmp_eq_u32 s37, 0
    s_mov_b32 s77, 114688
    s_cselect_b32 s77, s77, 4294852608
    s_add_u32 s68, s67, s77
    s_add_u32 s36, s36, s37
    s_lshl_b32 s70, s36, 15
    s_and_b32 s37, s73, 1
    s_lshl_b32 s37, s37, 14
    s_add_u32 s70, s70, s37
    s_add_u32 s70, s70, 0xc40000
    v_bfe_u32 v192, v0, 2, 2
    v_lshrrev_b32 v193, 5, v0
    v_bfe_u32 v194, v0, 4, 1
    v_bfe_u32 v195, v0, 1, 1
    v_and_b32 v196, 1, v0
    v_lshl_add_u32 v197, v193, 2, v192
    v_lshlrev_b32 v197, 7, v197
    v_lshl_add_u32 v197, v196, 3, v197
    v_lshl_add_u32 v194, v194, 1, v195
    v_lshrrev_b32 v192, 1, v192
    v_lshlrev_b32 v192, 2, v192
    s_and_b32 s38, s73, 1
    s_mul_i32 s39, s38, 30720
    s_add_u32 s39, s39, 0
    s_lshl_b32 s38, s38, 2
    v_xor_b32 v195, 0, v194
    v_xor_b32 v195, s38, v195
    v_xor_b32 v195, v195, v192
    v_lshl_add_u32 v195, v195, 4, v197
    v_add_u32 v3, s83, v195
    v_add_u32 v5, s39, v195
    v_xor_b32 v195, 4, v194
    v_xor_b32 v195, s38, v195
    v_xor_b32 v195, v195, v192
    v_lshl_add_u32 v195, v195, 4, v197
    v_add_u32 v4, s83, v195
    v_add_u32 v6, s39, v195
    s_lshr_b32 s36, s73, 1
    s_lshl_b32 s37, s65, 1
    s_add_u32 s36, s36, s37
    s_lshl_b32 s36, s36, 5
    s_mul_i32 s36, s36, 896
    s_lshl_b32 s37, s66, 7
    s_add_u32 s36, s36, s37
    s_and_b32 s37, s73, 1
    s_lshl_b32 s37, s37, 6
    s_add_u32 s36, s36, s37
    v_and_b32 v192, 31, v0
    v_mul_u32_u24 v192, 896, v192
    v_add_u32 v192, s36, v192
    v_lshl_add_u32 v9, v193, 3, v192
    v_lshl_add_u32 v10, v193, 4, v192
    s_waitcnt vmcnt(0)
    v_mov_b32 v192, 163328
    v_mov_b32 v193, 1
    s_mov_b64 exec, 1
    ds_add_rtn_u32 v193, v192, v193
    s_waitcnt lgkmcnt(0)
    v_cmp_eq_u32 vcc, 7, v193
    s_cbranch_vccz L_parallel_sum__softmax_full_mha__glu_gated_swiglu__prompt_kernel_hdg
    s_lshl_b32 s37, s29, 4
    s_add_u32 s37, s37, s30
    s_lshl_b32 s37, s37, 2
    s_add_u32 s37, s37, 0x1201000
    v_mov_b32 v192, 0
    v_mov_b32 v193, 1
    buffer_store_dword v193, v192, s[4:7], s37 offen sc1
L_parallel_sum__softmax_full_mha__glu_gated_swiglu__prompt_kernel_hdg:
    s_mov_b64 exec, -1
    s_add_u32 m0, s83, 0
    s_add_u32 s36, s69, 0
    buffer_load_dwordx4 v2, s[12:15], s36 offen lds
    s_add_u32 m0, s83, 1024
    s_add_u32 s36, s69, 7168
    buffer_load_dwordx4 v2, s[12:15], s36 offen lds
    s_add_u32 m0, s83, 2048
    s_add_u32 s36, s69, 114688
    buffer_load_dwordx4 v2, s[12:15], s36 offen lds
    s_add_u32 m0, s83, 3072
    s_add_u32 s36, s69, 121856
    buffer_load_dwordx4 v2, s[12:15], s36 offen lds
    s_add_u32 m0, s83, 4096
    s_add_u32 s36, s69, 229376
    buffer_load_dwordx4 v2, s[12:15], s36 offen lds
    s_add_u32 m0, s83, 5120
    s_add_u32 s36, s69, 236544
    buffer_load_dwordx4 v2, s[12:15], s36 offen lds
    s_add_u32 m0, s83, 6144
    s_add_u32 s36, s69, 344064
    buffer_load_dwordx4 v2, s[12:15], s36 offen lds
    s_add_u32 m0, s83, 7168
    s_add_u32 s36, s69, 351232
    buffer_load_dwordx4 v2, s[12:15], s36 offen lds
    v_mov_b32 v194, 163348
    s_cmp_eq_u32 s73, 0
    s_cbranch_scc0 L_parallel_sum__softmax_full_mha__glu_gated_swiglu__prompt_kernel_ghl0
    s_lshr_b32 s39, s65, 1
    s_lshl_b32 s39, s39, 6
    s_add_u32 s39, s39, 0x1201800
    v_lshlrev_b32 v192, 2, v0
    s_mov_b64 exec, 0x3fff
    s_mov_b32 s91, 200000
L_parallel_sum__softmax_full_mha__glu_gated_swiglu__prompt_kernel_gh0:
    buffer_load_dword v193, v192, s[4:7], s39 offen sc1
    s_waitcnt vmcnt(0)
    v_cmp_ne_u32 vcc, 1, v193
    s_cbranch_vccz L_parallel_sum__softmax_full_mha__glu_gated_swiglu__prompt_kernel_gh0_ok
    s_sub_u32 s91, s91, 1
    s_cbranch_scc1 L_parallel_sum__softmax_full_mha__glu_gated_swiglu__prompt_kernel_gh0_ok
    s_sleep 4
    s_branch L_parallel_sum__softmax_full_mha__glu_gated_swiglu__prompt_kernel_gh0
L_parallel_sum__softmax_full_mha__glu_gated_swiglu__prompt_kernel_gh0_ok:
    s_mov_b64 exec, -1
    v_mov_b32 v193, 1
    ds_write_b32 v194, v193
    s_waitcnt lgkmcnt(0)
    s_branch L_parallel_sum__softmax_full_mha__glu_gated_swiglu__prompt_kernel_ghd0
L_parallel_sum__softmax_full_mha__glu_gated_swiglu__prompt_kernel_ghl0:
    v_mov_b32 v192, 163348
    s_mov_b32 s91, 1600000
L_parallel_sum__softmax_full_mha__glu_gated_swiglu__prompt_kernel_ghw0:
    ds_read_b32 v193, v192
    s_waitcnt lgkmcnt(0)
    v_cmp_ne_u32 vcc, 1, v193
    s_cbranch_vccz L_parallel_sum__softmax_full_mha__glu_gated_swiglu__prompt_kernel_ghw0_ok
    s_sub_u32 s91, s91, 1
    s_cbranch_scc1 L_parallel_sum__softmax_full_mha__glu_gated_swiglu__prompt_kernel_ghw0_ok
    s_sleep 2
    s_branch L_parallel_sum__softmax_full_mha__glu_gated_swiglu__prompt_kernel_ghw0
L_parallel_sum__softmax_full_mha__glu_gated_swiglu__prompt_kernel_ghw0_ok:
L_parallel_sum__softmax_full_mha__glu_gated_swiglu__prompt_kernel_ghd0:
    s_waitcnt vmcnt(0)
    s_add_u32 s36, s67, 0
    buffer_load_dwordx4 v[16:19], v1, s[4:7], s36 offen sc1
    s_add_u32 s36, s68, 0
    buffer_load_dwordx4 v[20:23], v1, s[4:7], s36 offen sc1
    s_add_u32 s36, s67, 8192
    buffer_load_dwordx4 v[24:27], v1, s[4:7], s36 offen sc1
    s_add_u32 s36, s68, 8192
    buffer_load_dwordx4 v[28:31], v1, s[4:7], s36 offen sc1
    s_add_u32 s36, s67, 16384
    buffer_load_dwordx4 v[32:35], v1, s[4:7], s36 offen sc1
    s_add_u32 s36, s68, 16384
    buffer_load_dwordx4 v[36:39], v1, s[4:7], s36 offen sc1
    s_add_u32 s36, s67, 24576
    buffer_load_dwordx4 v[40:43], v1, s[4:7], s36 offen sc1
    s_add_u32 s36, s68, 24576
    buffer_load_dwordx4 v[44:47], v1, s[4:7], s36 offen sc1
    s_add_u32 s36, s67, 32768
    buffer_load_dwordx4 v[48:51], v1, s[4:7], s36 offen sc1
    s_add_u32 s36, s68, 32768
    buffer_load_dwordx4 v[52:55], v1, s[4:7], s36 offen sc1
    s_add_u32 m0, s83, 8192
    s_add_u32 s36, s69, 458752
    buffer_load_dwordx4 v2, s[12:15], s36 offen lds
    s_add_u32 m0, s83, 9216
    s_add_u32 s36, s69, 465920
    buffer_load_dwordx4 v2, s[12:15], s36 offen lds
    s_add_u32 m0, s83, 10240
    s_add_u32 s36, s69, 573440
    buffer_load_dwordx4 v2, s[12:15], s36 offen lds
    s_add_u32 m0, s83, 11264
    s_add_u32 s36, s69, 580608
    buffer_load_dwordx4 v2, s[12:15], s36 offen lds
    s_add_u32 m0, s83, 12288
    s_add_u32 s36, s69, 688128
    buffer_load_dwordx4 v2, s[12:15], s36 offen lds
    s_add_u32 m0, s83, 13312
    s_add_u32 s36, s69, 695296
    buffer_load_dwordx4 v2, s[12:15], s36 offen lds
    s_add_u32 m0, s83, 14336
    s_add_u32 s36, s69, 802816
    buffer_load_dwordx4 v2, s[12:15], s36 offen lds
    s_add_u32 m0, s83, 15360
    s_add_u32 s36, s69, 809984
    buffer_load_dwordx4 v2, s[12:15], s36 offen lds
    s_add_u32 m0, s83, 16384
    s_add_u32 s36, s69, 917504
    buffer_load_dwordx4 v2, s[12:15], s36 offen lds
    s_add_u32 m0, s83, 17408
    s_add_u32 s36, s69, 924672
    buffer_load_dwordx4 v2, s[12:15], s36 offen lds
    s_add_u32 m0, s83, 18432
    s_add_u32 s36, s69, 1032192
    buffer_load_dwordx4 v2, s[12:15], s36 offen lds
    s_add_u32 m0, s83, 19456
    s_add_u32 s36, s69, 1039360
    buffer_load_dwordx4 v2, s[12:15], s36 offen lds
    ds_read_b64_tr_b16 v[104:105], v3 offset:0
    ds_read_b64_tr_b16 v[106:107], v3 offset:1024
    ds_read_b64_tr_b16 v[108:109], v4 offset:0
    ds_read_b64_tr_b16 v[110:111], v4 offset:1024
    s_and_b32 s36, s73, 1
    s_lshr_b32 s37, s73, 1
    s_mul_i32 s75, s36, 224
    s_mul_i32 s38, s37, 120
    s_add_u32 s75, s75, s38
    s_mul_i32 s75, s75, 896
    s_lshl_b32 s38, s66, 7
    s_add_u32 s75, s75, s38
    s_mul_i32 s76, s36, 30720
    s_add_u32 s76, s76, 0
    s_mul_i32 s38, s37, 15360
    s_add_u32 s76, s76, s38
    s_add_u32 s36, s67, 40960
    buffer_load_dwordx4 v[56:59], v1, s[4:7], s36 offen sc1
    s_add_u32 s36, s68, 40960
    buffer_load_dwordx4 v[60:63], v1, s[4:7], s36 offen sc1
    s_add_u32 m0, s83, 20480
    s_add_u32 s36, s69, 1146880
    buffer_load_dwordx4 v2, s[12:15], s36 offen lds
    s_add_u32 m0, s83, 21504
    s_add_u32 s36, s69, 1154048
    buffer_load_dwordx4 v2, s[12:15], s36 offen lds
    ds_read_b64_tr_b16 v[112:113], v3 offset:2048
    ds_read_b64_tr_b16 v[114:115], v3 offset:3072
    ds_read_b64_tr_b16 v[116:117], v4 offset:2048
    ds_read_b64_tr_b16 v[118:119], v4 offset:3072
    s_waitcnt vmcnt(24)
    s_waitcnt lgkmcnt(4)
    v_mfma_f32_32x32x16_bf16 v[120:135], v[104:107], v[16:19], 0
    v_mfma_f32_32x32x16_bf16 v[136:151], v[108:111], v[16:19], 0
    v_mfma_f32_32x32x16_bf16 v[152:167], v[104:107], v[20:23], 0
    v_mfma_f32_32x32x16_bf16 v[168:183], v[108:111], v[20:23], 0
    s_add_u32 s36, s67, 49152
    buffer_load_dwordx4 v[16:19], v1, s[4:7], s36 offen sc1
    s_add_u32 s36, s68, 49152
    buffer_load_dwordx4 v[20:23], v1, s[4:7], s36 offen sc1
    s_add_u32 m0, s83, 22528
    s_add_u32 s36, s69, 1261568
    buffer_load_dwordx4 v2, s[12:15], s36 offen lds
    s_add_u32 m0, s83, 23552
    s_add_u32 s36, s69, 1268736
    buffer_load_dwordx4 v2, s[12:15], s36 offen lds
    ds_read_b64_tr_b16 v[104:105], v3 offset:4096
    ds_read_b64_tr_b16 v[106:107], v3 offset:5120
    ds_read_b64_tr_b16 v[108:109], v4 offset:4096
    ds_read_b64_tr_b16 v[110:111], v4 offset:5120
    s_waitcnt vmcnt(26)
    s_waitcnt lgkmcnt(4)
    v_mfma_f32_32x32x16_bf16 v[120:135], v[112:115], v[24:27], v[120:135]
    v_mfma_f32_32x32x16_bf16 v[136:151], v[116:119], v[24:27], v[136:151]
    v_mfma_f32_32x32x16_bf16 v[152:167], v[112:115], v[28:31], v[152:167]
    v_mfma_f32_32x32x16_bf16 v[168:183], v[116:119], v[28:31], v[168:183]
    s_add_u32 s36, s67, 57344
    buffer_load_dwordx4 v[24:27], v1, s[4:7], s36 offen sc1
    s_add_u32 s36, s68, 57344
    buffer_load_dwordx4 v[28:31], v1, s[4:7], s36 offen sc1
    s_add_u32 m0, s83, 0
    s_add_u32 s36, s69, 1376256
    buffer_load_dwordx4 v2, s[12:15], s36 offen lds
    s_add_u32 m0, s83, 1024
    s_add_u32 s36, s69, 1383424
    buffer_load_dwordx4 v2, s[12:15], s36 offen lds
    ds_read_b64_tr_b16 v[112:113], v3 offset:6144
    ds_read_b64_tr_b16 v[114:115], v3 offset:7168
    ds_read_b64_tr_b16 v[116:117], v4 offset:6144
    ds_read_b64_tr_b16 v[118:119], v4 offset:7168
    s_waitcnt vmcnt(28)
    s_waitcnt lgkmcnt(4)
    v_mfma_f32_32x32x16_bf16 v[120:135], v[104:107], v[32:35], v[120:135]
    v_mfma_f32_32x32x16_bf16 v[136:151], v[108:111], v[32:35], v[136:151]
    v_mfma_f32_32x32x16_bf16 v[152:167], v[104:107], v[36:39], v[152:167]
    v_mfma_f32_32x32x16_bf16 v[168:183], v[108:111], v[36:39], v[168:183]
    s_add_u32 s36, s67, 65536
    buffer_load_dwordx4 v[32:35], v1, s[4:7], s36 offen sc1
    s_add_u32 s36, s68, 65536
    buffer_load_dwordx4 v[36:39], v1, s[4:7], s36 offen sc1
    s_add_u32 m0, s83, 2048
    s_add_u32 s36, s69, 1490944
    buffer_load_dwordx4 v2, s[12:15], s36 offen lds
    s_add_u32 m0, s83, 3072
    s_add_u32 s36, s69, 1498112
    buffer_load_dwordx4 v2, s[12:15], s36 offen lds
    s_waitcnt vmcnt(26)
    ds_read_b64_tr_b16 v[104:105], v3 offset:8192
    ds_read_b64_tr_b16 v[106:107], v3 offset:9216
    ds_read_b64_tr_b16 v[108:109], v4 offset:8192
    ds_read_b64_tr_b16 v[110:111], v4 offset:9216
    s_waitcnt vmcnt(30)
    s_waitcnt lgkmcnt(4)
    v_mfma_f32_32x32x16_bf16 v[120:135], v[112:115], v[40:43], v[120:135]
    v_mfma_f32_32x32x16_bf16 v[136:151], v[116:119], v[40:43], v[136:151]
    v_mfma_f32_32x32x16_bf16 v[152:167], v[112:115], v[44:47], v[152:167]
    v_mfma_f32_32x32x16_bf16 v[168:183], v[116:119], v[44:47], v[168:183]
    s_add_u32 s36, s67, 73728
    buffer_load_dwordx4 v[40:43], v1, s[4:7], s36 offen sc1
    s_add_u32 s36, s68, 73728
    buffer_load_dwordx4 v[44:47], v1, s[4:7], s36 offen sc1
    s_add_u32 m0, s83, 4096
    s_add_u32 s36, s69, 57344
    buffer_load_dwordx4 v2, s[12:15], s36 offen lds
    s_add_u32 m0, s83, 5120
    s_add_u32 s36, s69, 64512
    buffer_load_dwordx4 v2, s[12:15], s36 offen lds
    s_waitcnt vmcnt(28)
    ds_read_b64_tr_b16 v[112:113], v3 offset:10240
    ds_read_b64_tr_b16 v[114:115], v3 offset:11264
    ds_read_b64_tr_b16 v[116:117], v4 offset:10240
    ds_read_b64_tr_b16 v[118:119], v4 offset:11264
    s_waitcnt vmcnt(32)
    s_waitcnt lgkmcnt(4)
    v_mfma_f32_32x32x16_bf16 v[120:135], v[104:107], v[48:51], v[120:135]
    v_mfma_f32_32x32x16_bf16 v[136:151], v[108:111], v[48:51], v[136:151]
    v_mfma_f32_32x32x16_bf16 v[152:167], v[104:107], v[52:55], v[152:167]
    v_mfma_f32_32x32x16_bf16 v[168:183], v[108:111], v[52:55], v[168:183]
    s_add_u32 s36, s67, 81920
    buffer_load_dwordx4 v[48:51], v1, s[4:7], s36 offen sc1
    s_add_u32 s36, s68, 81920
    buffer_load_dwordx4 v[52:55], v1, s[4:7], s36 offen sc1
    s_add_u32 m0, s83, 6144
    s_add_u32 s36, s69, 172032
    buffer_load_dwordx4 v2, s[12:15], s36 offen lds
    s_add_u32 m0, s83, 7168
    s_add_u32 s36, s69, 179200
    buffer_load_dwordx4 v2, s[12:15], s36 offen lds
    s_waitcnt vmcnt(30)
    ds_read_b64_tr_b16 v[104:105], v3 offset:12288
    ds_read_b64_tr_b16 v[106:107], v3 offset:13312
    ds_read_b64_tr_b16 v[108:109], v4 offset:12288
    ds_read_b64_tr_b16 v[110:111], v4 offset:13312
    s_waitcnt vmcnt(22)
    s_waitcnt lgkmcnt(4)
    v_mfma_f32_32x32x16_bf16 v[120:135], v[112:115], v[56:59], v[120:135]
    v_mfma_f32_32x32x16_bf16 v[136:151], v[116:119], v[56:59], v[136:151]
    v_mfma_f32_32x32x16_bf16 v[152:167], v[112:115], v[60:63], v[152:167]
    v_mfma_f32_32x32x16_bf16 v[168:183], v[116:119], v[60:63], v[168:183]
    s_add_u32 s36, s67, 90112
    buffer_load_dwordx4 v[56:59], v1, s[4:7], s36 offen sc1
    s_add_u32 s36, s68, 90112
    buffer_load_dwordx4 v[60:63], v1, s[4:7], s36 offen sc1
    s_add_u32 m0, s83, 8192
    s_add_u32 s36, s69, 286720
    buffer_load_dwordx4 v2, s[12:15], s36 offen lds
    s_add_u32 m0, s83, 9216
    s_add_u32 s36, s69, 293888
    buffer_load_dwordx4 v2, s[12:15], s36 offen lds
    s_waitcnt vmcnt(32)
    ds_read_b64_tr_b16 v[112:113], v3 offset:14336
    ds_read_b64_tr_b16 v[114:115], v3 offset:15360
    ds_read_b64_tr_b16 v[116:117], v4 offset:14336
    ds_read_b64_tr_b16 v[118:119], v4 offset:15360
    s_waitcnt vmcnt(22)
    s_waitcnt lgkmcnt(4)
    v_mfma_f32_32x32x16_bf16 v[120:135], v[104:107], v[16:19], v[120:135]
    v_mfma_f32_32x32x16_bf16 v[136:151], v[108:111], v[16:19], v[136:151]
    v_mfma_f32_32x32x16_bf16 v[152:167], v[104:107], v[20:23], v[152:167]
    v_mfma_f32_32x32x16_bf16 v[168:183], v[108:111], v[20:23], v[168:183]
    s_add_u32 s36, s67, 98304
    buffer_load_dwordx4 v[16:19], v1, s[4:7], s36 offen sc1
    s_add_u32 s36, s68, 98304
    buffer_load_dwordx4 v[20:23], v1, s[4:7], s36 offen sc1
    s_add_u32 m0, s83, 10240
    s_add_u32 s36, s69, 401408
    buffer_load_dwordx4 v2, s[12:15], s36 offen lds
    s_add_u32 m0, s83, 11264
    s_add_u32 s36, s69, 408576
    buffer_load_dwordx4 v2, s[12:15], s36 offen lds
    s_waitcnt vmcnt(34)
    ds_read_b64_tr_b16 v[104:105], v3 offset:16384
    ds_read_b64_tr_b16 v[106:107], v3 offset:17408
    ds_read_b64_tr_b16 v[108:109], v4 offset:16384
    ds_read_b64_tr_b16 v[110:111], v4 offset:17408
    s_waitcnt vmcnt(22)
    s_waitcnt lgkmcnt(4)
    v_mfma_f32_32x32x16_bf16 v[120:135], v[112:115], v[24:27], v[120:135]
    v_mfma_f32_32x32x16_bf16 v[136:151], v[116:119], v[24:27], v[136:151]
    v_mfma_f32_32x32x16_bf16 v[152:167], v[112:115], v[28:31], v[152:167]
    v_mfma_f32_32x32x16_bf16 v[168:183], v[116:119], v[28:31], v[168:183]
    s_add_u32 s36, s67, 106496
    buffer_load_dwordx4 v[24:27], v1, s[4:7], s36 offen sc1
    s_add_u32 s36, s68, 106496
    buffer_load_dwordx4 v[28:31], v1, s[4:7], s36 offen sc1
    s_add_u32 m0, s83, 12288
    s_add_u32 s36, s69, 516096
    buffer_load_dwordx4 v2, s[12:15], s36 offen lds
    s_add_u32 m0, s83, 13312
    s_add_u32 s36, s69, 523264
    buffer_load_dwordx4 v2, s[12:15], s36 offen lds
    s_waitcnt vmcnt(36)
    ds_read_b64_tr_b16 v[112:113], v3 offset:18432
    ds_read_b64_tr_b16 v[114:115], v3 offset:19456
    ds_read_b64_tr_b16 v[116:117], v4 offset:18432
    ds_read_b64_tr_b16 v[118:119], v4 offset:19456
    s_waitcnt vmcnt(22)
    s_waitcnt lgkmcnt(4)
    v_mfma_f32_32x32x16_bf16 v[120:135], v[104:107], v[32:35], v[120:135]
    v_mfma_f32_32x32x16_bf16 v[136:151], v[108:111], v[32:35], v[136:151]
    v_mfma_f32_32x32x16_bf16 v[152:167], v[104:107], v[36:39], v[152:167]
    v_mfma_f32_32x32x16_bf16 v[168:183], v[108:111], v[36:39], v[168:183]
    v_mov_b32 v194, 163332
    s_cmp_eq_u32 s73, 0
    s_cbranch_scc0 L_parallel_sum__softmax_full_mha__glu_gated_swiglu__prompt_kernel_ghl1
    s_lshr_b32 s39, s65, 1
    s_lshl_b32 s39, s39, 6
    s_add_u32 s39, s39, 0x1201000
    v_lshlrev_b32 v192, 2, v0
    s_mov_b64 exec, 0x3fff
    s_mov_b32 s91, 200000
L_parallel_sum__softmax_full_mha__glu_gated_swiglu__prompt_kernel_gh1:
    buffer_load_dword v193, v192, s[4:7], s39 offen sc1
    s_waitcnt vmcnt(0)
    v_cmp_ne_u32 vcc, 1, v193
    s_cbranch_vccz L_parallel_sum__softmax_full_mha__glu_gated_swiglu__prompt_kernel_gh1_ok
    s_sub_u32 s91, s91, 1
    s_cbranch_scc1 L_parallel_sum__softmax_full_mha__glu_gated_swiglu__prompt_kernel_gh1_ok
    s_sleep 4
    s_branch L_parallel_sum__softmax_full_mha__glu_gated_swiglu__prompt_kernel_gh1
L_parallel_sum__softmax_full_mha__glu_gated_swiglu__prompt_kernel_gh1_ok:
    s_mov_b64 exec, -1
    v_mov_b32 v193, 1
    ds_write_b32 v194, v193
    s_waitcnt lgkmcnt(0)
    s_branch L_parallel_sum__softmax_full_mha__glu_gated_swiglu__prompt_kernel_ghd1
L_parallel_sum__softmax_full_mha__glu_gated_swiglu__prompt_kernel_ghl1:
    v_mov_b32 v192, 163332
    s_mov_b32 s91, 1600000
L_parallel_sum__softmax_full_mha__glu_gated_swiglu__prompt_kernel_ghw1:
    ds_read_b32 v193, v192
    s_waitcnt lgkmcnt(0)
    v_cmp_ne_u32 vcc, 1, v193
    s_cbranch_vccz L_parallel_sum__softmax_full_mha__glu_gated_swiglu__prompt_kernel_ghw1_ok
    s_sub_u32 s91, s91, 1
    s_cbranch_scc1 L_parallel_sum__softmax_full_mha__glu_gated_swiglu__prompt_kernel_ghw1_ok
    s_sleep 2
    s_branch L_parallel_sum__softmax_full_mha__glu_gated_swiglu__prompt_kernel_ghw1
L_parallel_sum__softmax_full_mha__glu_gated_swiglu__prompt_kernel_ghw1_ok:
L_parallel_sum__softmax_full_mha__glu_gated_swiglu__prompt_kernel_ghd1:
    s_add_u32 s36, s67, 4096
    buffer_load_dwordx4 v[32:35], v1, s[4:7], s36 offen sc1
    s_add_u32 s36, s68, 4096
    buffer_load_dwordx4 v[36:39], v1, s[4:7], s36 offen sc1
    s_add_u32 m0, s83, 14336
    s_add_u32 s36, s69, 630784
    buffer_load_dwordx4 v2, s[12:15], s36 offen lds
    s_add_u32 m0, s83, 15360
    s_add_u32 s36, s69, 637952
    buffer_load_dwordx4 v2, s[12:15], s36 offen lds
    s_waitcnt vmcnt(36)
    ds_read_b64_tr_b16 v[104:105], v3 offset:20480
    ds_read_b64_tr_b16 v[106:107], v3 offset:21504
    ds_read_b64_tr_b16 v[108:109], v4 offset:20480
    ds_read_b64_tr_b16 v[110:111], v4 offset:21504
    s_waitcnt vmcnt(22)
    s_waitcnt lgkmcnt(4)
    v_mfma_f32_32x32x16_bf16 v[120:135], v[112:115], v[40:43], v[120:135]
    v_mfma_f32_32x32x16_bf16 v[136:151], v[116:119], v[40:43], v[136:151]
    v_mfma_f32_32x32x16_bf16 v[152:167], v[112:115], v[44:47], v[152:167]
    v_mfma_f32_32x32x16_bf16 v[168:183], v[116:119], v[44:47], v[168:183]
    s_add_u32 s36, s67, 12288
    buffer_load_dwordx4 v[40:43], v1, s[4:7], s36 offen sc1
    s_add_u32 s36, s68, 12288
    buffer_load_dwordx4 v[44:47], v1, s[4:7], s36 offen sc1
    s_add_u32 m0, s83, 16384
    s_add_u32 s36, s69, 745472
    buffer_load_dwordx4 v2, s[12:15], s36 offen lds
    s_add_u32 m0, s83, 17408
    s_add_u32 s36, s69, 752640
    buffer_load_dwordx4 v2, s[12:15], s36 offen lds
    s_waitcnt vmcnt(36)
    ds_read_b64_tr_b16 v[112:113], v3 offset:22528
    ds_read_b64_tr_b16 v[114:115], v3 offset:23552
    ds_read_b64_tr_b16 v[116:117], v4 offset:22528
    ds_read_b64_tr_b16 v[118:119], v4 offset:23552
    s_waitcnt vmcnt(22)
    s_waitcnt lgkmcnt(4)
    v_mfma_f32_32x32x16_bf16 v[120:135], v[104:107], v[48:51], v[120:135]
    v_mfma_f32_32x32x16_bf16 v[136:151], v[108:111], v[48:51], v[136:151]
    v_mfma_f32_32x32x16_bf16 v[152:167], v[104:107], v[52:55], v[152:167]
    v_mfma_f32_32x32x16_bf16 v[168:183], v[108:111], v[52:55], v[168:183]
    s_add_u32 s36, s67, 20480
    buffer_load_dwordx4 v[48:51], v1, s[4:7], s36 offen sc1
    s_add_u32 s36, s68, 20480
    buffer_load_dwordx4 v[52:55], v1, s[4:7], s36 offen sc1
    s_add_u32 m0, s83, 18432
    s_add_u32 s36, s69, 860160
    buffer_load_dwordx4 v2, s[12:15], s36 offen lds
    s_add_u32 m0, s83, 19456
    s_add_u32 s36, s69, 867328
    buffer_load_dwordx4 v2, s[12:15], s36 offen lds
    s_waitcnt vmcnt(36)
    ds_read_b64_tr_b16 v[104:105], v3 offset:0
    ds_read_b64_tr_b16 v[106:107], v3 offset:1024
    ds_read_b64_tr_b16 v[108:109], v4 offset:0
    ds_read_b64_tr_b16 v[110:111], v4 offset:1024
    s_waitcnt vmcnt(22)
    s_waitcnt lgkmcnt(4)
    v_mfma_f32_32x32x16_bf16 v[120:135], v[112:115], v[56:59], v[120:135]
    v_mfma_f32_32x32x16_bf16 v[136:151], v[116:119], v[56:59], v[136:151]
    v_mfma_f32_32x32x16_bf16 v[152:167], v[112:115], v[60:63], v[152:167]
    v_mfma_f32_32x32x16_bf16 v[168:183], v[116:119], v[60:63], v[168:183]
    s_add_u32 s36, s67, 28672
    buffer_load_dwordx4 v[56:59], v1, s[4:7], s36 offen sc1
    s_add_u32 s36, s68, 28672
    buffer_load_dwordx4 v[60:63], v1, s[4:7], s36 offen sc1
    s_add_u32 m0, s83, 20480
    s_add_u32 s36, s69, 974848
    buffer_load_dwordx4 v2, s[12:15], s36 offen lds
    s_add_u32 m0, s83, 21504
    s_add_u32 s36, s69, 982016
    buffer_load_dwordx4 v2, s[12:15], s36 offen lds
    s_waitcnt vmcnt(36)
    ds_read_b64_tr_b16 v[112:113], v3 offset:2048
    ds_read_b64_tr_b16 v[114:115], v3 offset:3072
    ds_read_b64_tr_b16 v[116:117], v4 offset:2048
    ds_read_b64_tr_b16 v[118:119], v4 offset:3072
    s_waitcnt vmcnt(22)
    s_waitcnt lgkmcnt(4)
    v_mfma_f32_32x32x16_bf16 v[120:135], v[104:107], v[16:19], v[120:135]
    v_mfma_f32_32x32x16_bf16 v[136:151], v[108:111], v[16:19], v[136:151]
    v_mfma_f32_32x32x16_bf16 v[152:167], v[104:107], v[20:23], v[152:167]
    v_mfma_f32_32x32x16_bf16 v[168:183], v[108:111], v[20:23], v[168:183]
    s_add_u32 s36, s67, 36864
    buffer_load_dwordx4 v[16:19], v1, s[4:7], s36 offen sc1
    s_add_u32 s36, s68, 36864
    buffer_load_dwordx4 v[20:23], v1, s[4:7], s36 offen sc1
    s_add_u32 m0, s83, 22528
    s_add_u32 s36, s69, 1089536
    buffer_load_dwordx4 v2, s[12:15], s36 offen lds
    s_add_u32 m0, s83, 23552
    s_add_u32 s36, s69, 1096704
    buffer_load_dwordx4 v2, s[12:15], s36 offen lds
    s_waitcnt vmcnt(36)
    ds_read_b64_tr_b16 v[104:105], v3 offset:4096
    ds_read_b64_tr_b16 v[106:107], v3 offset:5120
    ds_read_b64_tr_b16 v[108:109], v4 offset:4096
    ds_read_b64_tr_b16 v[110:111], v4 offset:5120
    s_waitcnt vmcnt(22)
    s_waitcnt lgkmcnt(4)
    v_mfma_f32_32x32x16_bf16 v[120:135], v[112:115], v[24:27], v[120:135]
    v_mfma_f32_32x32x16_bf16 v[136:151], v[116:119], v[24:27], v[136:151]
    v_mfma_f32_32x32x16_bf16 v[152:167], v[112:115], v[28:31], v[152:167]
    v_mfma_f32_32x32x16_bf16 v[168:183], v[116:119], v[28:31], v[168:183]
    s_add_u32 s36, s67, 45056
    buffer_load_dwordx4 v[24:27], v1, s[4:7], s36 offen sc1
    s_add_u32 s36, s68, 45056
    buffer_load_dwordx4 v[28:31], v1, s[4:7], s36 offen sc1
    s_add_u32 m0, s83, 0
    s_add_u32 s36, s69, 1204224
    buffer_load_dwordx4 v2, s[12:15], s36 offen lds
    s_add_u32 m0, s83, 1024
    s_add_u32 s36, s69, 1211392
    buffer_load_dwordx4 v2, s[12:15], s36 offen lds
    s_waitcnt vmcnt(36)
    ds_read_b64_tr_b16 v[112:113], v3 offset:6144
    ds_read_b64_tr_b16 v[114:115], v3 offset:7168
    ds_read_b64_tr_b16 v[116:117], v4 offset:6144
    ds_read_b64_tr_b16 v[118:119], v4 offset:7168
    s_waitcnt vmcnt(22)
    s_waitcnt lgkmcnt(4)
    v_mfma_f32_32x32x16_bf16 v[120:135], v[104:107], v[32:35], v[120:135]
    v_mfma_f32_32x32x16_bf16 v[136:151], v[108:111], v[32:35], v[136:151]
    v_mfma_f32_32x32x16_bf16 v[152:167], v[104:107], v[36:39], v[152:167]
    v_mfma_f32_32x32x16_bf16 v[168:183], v[108:111], v[36:39], v[168:183]
    s_add_u32 s36, s67, 53248
    buffer_load_dwordx4 v[32:35], v1, s[4:7], s36 offen sc1
    s_add_u32 s36, s68, 53248
    buffer_load_dwordx4 v[36:39], v1, s[4:7], s36 offen sc1
    s_add_u32 m0, s83, 2048
    s_add_u32 s36, s69, 1318912
    buffer_load_dwordx4 v2, s[12:15], s36 offen lds
    s_add_u32 m0, s83, 3072
    s_add_u32 s36, s69, 1326080
    buffer_load_dwordx4 v2, s[12:15], s36 offen lds
    s_waitcnt vmcnt(36)
    ds_read_b64_tr_b16 v[104:105], v3 offset:8192
    ds_read_b64_tr_b16 v[106:107], v3 offset:9216
    ds_read_b64_tr_b16 v[108:109], v4 offset:8192
    ds_read_b64_tr_b16 v[110:111], v4 offset:9216
    s_waitcnt vmcnt(22)
    s_waitcnt lgkmcnt(4)
    v_mfma_f32_32x32x16_bf16 v[120:135], v[112:115], v[40:43], v[120:135]
    v_mfma_f32_32x32x16_bf16 v[136:151], v[116:119], v[40:43], v[136:151]
    v_mfma_f32_32x32x16_bf16 v[152:167], v[112:115], v[44:47], v[152:167]
    v_mfma_f32_32x32x16_bf16 v[168:183], v[116:119], v[44:47], v[168:183]
    s_add_u32 s36, s67, 61440
    buffer_load_dwordx4 v[40:43], v1, s[4:7], s36 offen sc1
    s_add_u32 s36, s68, 61440
    buffer_load_dwordx4 v[44:47], v1, s[4:7], s36 offen sc1
    s_add_u32 m0, s83, 4096
    s_add_u32 s36, s69, 1433600
    buffer_load_dwordx4 v2, s[12:15], s36 offen lds
    s_add_u32 m0, s83, 5120
    s_add_u32 s36, s69, 1440768
    buffer_load_dwordx4 v2, s[12:15], s36 offen lds
    s_waitcnt vmcnt(36)
    ds_read_b64_tr_b16 v[112:113], v3 offset:10240
    ds_read_b64_tr_b16 v[114:115], v3 offset:11264
    ds_read_b64_tr_b16 v[116:117], v4 offset:10240
    ds_read_b64_tr_b16 v[118:119], v4 offset:11264
    s_waitcnt vmcnt(22)
    s_waitcnt lgkmcnt(4)
    v_mfma_f32_32x32x16_bf16 v[120:135], v[104:107], v[48:51], v[120:135]
    v_mfma_f32_32x32x16_bf16 v[136:151], v[108:111], v[48:51], v[136:151]
    v_mfma_f32_32x32x16_bf16 v[152:167], v[104:107], v[52:55], v[152:167]
    v_mfma_f32_32x32x16_bf16 v[168:183], v[108:111], v[52:55], v[168:183]
    s_add_u32 s36, s67, 69632
    buffer_load_dwordx4 v[48:51], v1, s[4:7], s36 offen sc1
    s_add_u32 s36, s68, 69632
    buffer_load_dwordx4 v[52:55], v1, s[4:7], s36 offen sc1
    s_add_u32 m0, s83, 6144
    s_add_u32 s36, s69, 1548288
    buffer_load_dwordx4 v2, s[12:15], s36 offen lds
    s_add_u32 m0, s83, 7168
    s_add_u32 s36, s69, 1555456
    buffer_load_dwordx4 v2, s[12:15], s36 offen lds
    s_waitcnt vmcnt(36)
    ds_read_b64_tr_b16 v[104:105], v3 offset:12288
    ds_read_b64_tr_b16 v[106:107], v3 offset:13312
    ds_read_b64_tr_b16 v[108:109], v4 offset:12288
    ds_read_b64_tr_b16 v[110:111], v4 offset:13312
    s_waitcnt vmcnt(22)
    s_waitcnt lgkmcnt(4)
    v_mfma_f32_32x32x16_bf16 v[120:135], v[112:115], v[56:59], v[120:135]
    v_mfma_f32_32x32x16_bf16 v[136:151], v[116:119], v[56:59], v[136:151]
    v_mfma_f32_32x32x16_bf16 v[152:167], v[112:115], v[60:63], v[152:167]
    v_mfma_f32_32x32x16_bf16 v[168:183], v[116:119], v[60:63], v[168:183]
    s_add_u32 s36, s67, 77824
    buffer_load_dwordx4 v[56:59], v1, s[4:7], s36 offen sc1
    s_add_u32 s36, s68, 77824
    buffer_load_dwordx4 v[60:63], v1, s[4:7], s36 offen sc1
    s_waitcnt vmcnt(34)
    ds_read_b64_tr_b16 v[112:113], v3 offset:14336
    ds_read_b64_tr_b16 v[114:115], v3 offset:15360
    ds_read_b64_tr_b16 v[116:117], v4 offset:14336
    ds_read_b64_tr_b16 v[118:119], v4 offset:15360
    s_waitcnt vmcnt(20)
    s_waitcnt lgkmcnt(4)
    v_mfma_f32_32x32x16_bf16 v[120:135], v[104:107], v[16:19], v[120:135]
    v_mfma_f32_32x32x16_bf16 v[136:151], v[108:111], v[16:19], v[136:151]
    v_mfma_f32_32x32x16_bf16 v[152:167], v[104:107], v[20:23], v[152:167]
    v_mfma_f32_32x32x16_bf16 v[168:183], v[108:111], v[20:23], v[168:183]
    s_add_u32 s36, s67, 86016
    buffer_load_dwordx4 v[16:19], v1, s[4:7], s36 offen sc1
    s_add_u32 s36, s68, 86016
    buffer_load_dwordx4 v[20:23], v1, s[4:7], s36 offen sc1
    s_waitcnt vmcnt(32)
    ds_read_b64_tr_b16 v[104:105], v3 offset:16384
    ds_read_b64_tr_b16 v[106:107], v3 offset:17408
    ds_read_b64_tr_b16 v[108:109], v4 offset:16384
    ds_read_b64_tr_b16 v[110:111], v4 offset:17408
    s_waitcnt vmcnt(18)
    s_waitcnt lgkmcnt(4)
    v_mfma_f32_32x32x16_bf16 v[120:135], v[112:115], v[24:27], v[120:135]
    v_mfma_f32_32x32x16_bf16 v[136:151], v[116:119], v[24:27], v[136:151]
    v_mfma_f32_32x32x16_bf16 v[152:167], v[112:115], v[28:31], v[152:167]
    v_mfma_f32_32x32x16_bf16 v[168:183], v[116:119], v[28:31], v[168:183]
    s_add_u32 s36, s67, 94208
    buffer_load_dwordx4 v[24:27], v1, s[4:7], s36 offen sc1
    s_add_u32 s36, s68, 94208
    buffer_load_dwordx4 v[28:31], v1, s[4:7], s36 offen sc1
    s_waitcnt vmcnt(30)
    ds_read_b64_tr_b16 v[112:113], v3 offset:18432
    ds_read_b64_tr_b16 v[114:115], v3 offset:19456
    ds_read_b64_tr_b16 v[116:117], v4 offset:18432
    ds_read_b64_tr_b16 v[118:119], v4 offset:19456
    s_waitcnt vmcnt(16)
    s_waitcnt lgkmcnt(4)
    v_mfma_f32_32x32x16_bf16 v[120:135], v[104:107], v[32:35], v[120:135]
    v_mfma_f32_32x32x16_bf16 v[136:151], v[108:111], v[32:35], v[136:151]
    v_mfma_f32_32x32x16_bf16 v[152:167], v[104:107], v[36:39], v[152:167]
    v_mfma_f32_32x32x16_bf16 v[168:183], v[108:111], v[36:39], v[168:183]
    s_add_u32 s36, s67, 102400
    buffer_load_dwordx4 v[32:35], v1, s[4:7], s36 offen sc1
    s_add_u32 s36, s68, 102400
    buffer_load_dwordx4 v[36:39], v1, s[4:7], s36 offen sc1
    s_waitcnt vmcnt(28)
    ds_read_b64_tr_b16 v[104:105], v3 offset:20480
    ds_read_b64_tr_b16 v[106:107], v3 offset:21504
    ds_read_b64_tr_b16 v[108:109], v4 offset:20480
    ds_read_b64_tr_b16 v[110:111], v4 offset:21504
    s_waitcnt vmcnt(14)
    s_waitcnt lgkmcnt(4)
    v_mfma_f32_32x32x16_bf16 v[120:135], v[112:115], v[40:43], v[120:135]
    v_mfma_f32_32x32x16_bf16 v[136:151], v[116:119], v[40:43], v[136:151]
    v_mfma_f32_32x32x16_bf16 v[152:167], v[112:115], v[44:47], v[152:167]
    v_mfma_f32_32x32x16_bf16 v[168:183], v[116:119], v[44:47], v[168:183]
    s_add_u32 s36, s67, 110592
    buffer_load_dwordx4 v[40:43], v1, s[4:7], s36 offen sc1
    s_add_u32 s36, s68, 110592
    buffer_load_dwordx4 v[44:47], v1, s[4:7], s36 offen sc1
    s_waitcnt vmcnt(26)
    ds_read_b64_tr_b16 v[112:113], v3 offset:22528
    ds_read_b64_tr_b16 v[114:115], v3 offset:23552
    ds_read_b64_tr_b16 v[116:117], v4 offset:22528
    ds_read_b64_tr_b16 v[118:119], v4 offset:23552
    s_waitcnt vmcnt(12)
    s_waitcnt lgkmcnt(4)
    v_mfma_f32_32x32x16_bf16 v[120:135], v[104:107], v[48:51], v[120:135]
    v_mfma_f32_32x32x16_bf16 v[136:151], v[108:111], v[48:51], v[136:151]
    v_mfma_f32_32x32x16_bf16 v[152:167], v[104:107], v[52:55], v[152:167]
    v_mfma_f32_32x32x16_bf16 v[168:183], v[108:111], v[52:55], v[168:183]
    s_waitcnt vmcnt(22)
    ds_read_b64_tr_b16 v[104:105], v3 offset:0
    ds_read_b64_tr_b16 v[106:107], v3 offset:1024
    ds_read_b64_tr_b16 v[108:109], v4 offset:0
    ds_read_b64_tr_b16 v[110:111], v4 offset:1024
    s_waitcnt vmcnt(8)
    s_waitcnt lgkmcnt(4)
    v_mfma_f32_32x32x16_bf16 v[120:135], v[112:115], v[56:59], v[120:135]
    v_mfma_f32_32x32x16_bf16 v[136:151], v[116:119], v[56:59], v[136:151]
    v_mfma_f32_32x32x16_bf16 v[152:167], v[112:115], v[60:63], v[152:167]
    v_mfma_f32_32x32x16_bf16 v[168:183], v[116:119], v[60:63], v[168:183]
    s_waitcnt vmcnt(18)
    ds_read_b64_tr_b16 v[112:113], v3 offset:2048
    ds_read_b64_tr_b16 v[114:115], v3 offset:3072
    ds_read_b64_tr_b16 v[116:117], v4 offset:2048
    ds_read_b64_tr_b16 v[118:119], v4 offset:3072
    s_waitcnt vmcnt(6)
    s_waitcnt lgkmcnt(4)
    v_mfma_f32_32x32x16_bf16 v[120:135], v[104:107], v[16:19], v[120:135]
    v_mfma_f32_32x32x16_bf16 v[136:151], v[108:111], v[16:19], v[136:151]
    v_mfma_f32_32x32x16_bf16 v[152:167], v[104:107], v[20:23], v[152:167]
    v_mfma_f32_32x32x16_bf16 v[168:183], v[108:111], v[20:23], v[168:183]
    s_waitcnt vmcnt(14)
    ds_read_b64_tr_b16 v[104:105], v3 offset:4096
    ds_read_b64_tr_b16 v[106:107], v3 offset:5120
    ds_read_b64_tr_b16 v[108:109], v4 offset:4096
    ds_read_b64_tr_b16 v[110:111], v4 offset:5120
    s_waitcnt vmcnt(4)
    s_waitcnt lgkmcnt(4)
    v_mfma_f32_32x32x16_bf16 v[120:135], v[112:115], v[24:27], v[120:135]
    v_mfma_f32_32x32x16_bf16 v[136:151], v[116:119], v[24:27], v[136:151]
    v_mfma_f32_32x32x16_bf16 v[152:167], v[112:115], v[28:31], v[152:167]
    v_mfma_f32_32x32x16_bf16 v[168:183], v[116:119], v[28:31], v[168:183]
    s_waitcnt vmcnt(10)
    ds_read_b64_tr_b16 v[112:113], v3 offset:6144
    ds_read_b64_tr_b16 v[114:115], v3 offset:7168
    ds_read_b64_tr_b16 v[116:117], v4 offset:6144
    ds_read_b64_tr_b16 v[118:119], v4 offset:7168
    s_waitcnt vmcnt(2)
    s_waitcnt lgkmcnt(4)
    v_mfma_f32_32x32x16_bf16 v[120:135], v[104:107], v[32:35], v[120:135]
    v_mfma_f32_32x32x16_bf16 v[136:151], v[108:111], v[32:35], v[136:151]
    v_mfma_f32_32x32x16_bf16 v[152:167], v[104:107], v[36:39], v[152:167]
    v_mfma_f32_32x32x16_bf16 v[168:183], v[108:111], v[36:39], v[168:183]
    s_waitcnt vmcnt(0)
    s_waitcnt lgkmcnt(0)
    v_mfma_f32_32x32x16_bf16 v[120:135], v[112:115], v[40:43], v[120:135]
    v_mfma_f32_32x32x16_bf16 v[136:151], v[116:119], v[40:43], v[136:151]
    v_mfma_f32_32x32x16_bf16 v[152:167], v[112:115], v[44:47], v[152:167]
    v_mfma_f32_32x32x16_bf16 v[168:183], v[116:119], v[44:47], v[168:183]
    buffer_load_dwordx2 v[184:185], v9, s[8:11], 0 offen offset:0
    buffer_load_dwordx2 v[186:187], v9, s[8:11], 0 offen offset:16
    buffer_load_dwordx2 v[188:189], v9, s[8:11], 0 offen offset:32
    buffer_load_dwordx2 v[190:191], v9, s[8:11], 0 offen offset:48
    v_add_u32 v7, s83, v1
    s_nop 7
    s_nop 1
    ds_write_b128 v7, v[136:139] offset:0
    ds_write_b128 v7, v[140:143] offset:1024
    ds_write_b128 v7, v[144:147] offset:2048
    ds_write_b128 v7, v[148:151] offset:3072
    ds_write_b128 v7, v[152:155] offset:4096
    ds_write_b128 v7, v[156:159] offset:5120
    ds_write_b128 v7, v[160:163] offset:6144
    ds_write_b128 v7, v[164:167] offset:7168
    ds_write_b128 v7, v[168:171] offset:8192
    ds_write_b128 v7, v[172:175] offset:9216
    ds_write_b128 v7, v[176:179] offset:10240
    ds_write_b128 v7, v[180:183] offset:11264
    s_xor_b32 s36, s73, 1
    s_mul_i32 s36, s36, 24576
    s_add_u32 s36, s36, 61440
    v_add_u32 v196, s36, v1
    s_xor_b32 s36, s73, 2
    s_mul_i32 s36, s36, 24576
    s_add_u32 s36, s36, 65536
    v_add_u32 v197, s36, v1
    s_xor_b32 s36, s73, 3
    s_mul_i32 s36, s36, 24576
    s_add_u32 s36, s36, 69632
    v_add_u32 v198, s36, v1
    v_mov_b32 v192, 163336
    v_mov_b32 v193, 1
    s_waitcnt lgkmcnt(0)
    s_mov_b64 exec, 1
    ds_add_u32 v192, v193
    s_mov_b64 exec, -1
    s_mov_b32 s91, 1600000
L_parallel_sum__softmax_full_mha__glu_gated_swiglu__prompt_kernel_rc:
    ds_read_b32 v193, v192
    s_waitcnt lgkmcnt(0)
    v_cmp_ne_u32 vcc, 4, v193
    s_cbranch_vccz L_parallel_sum__softmax_full_mha__glu_gated_swiglu__prompt_kernel_rcd
    s_sub_u32 s91, s91, 1
    s_cbranch_scc1 L_parallel_sum__softmax_full_mha__glu_gated_swiglu__prompt_kernel_rcd
    s_sleep 2
    s_branch L_parallel_sum__softmax_full_mha__glu_gated_swiglu__prompt_kernel_rc
L_parallel_sum__softmax_full_mha__glu_gated_swiglu__prompt_kernel_rcd:
    ds_read_b128 v[136:139], v196 offset:0
    ds_read_b128 v[140:143], v196 offset:1024
    ds_read_b128 v[144:147], v196 offset:2048
    ds_read_b128 v[148:151], v196 offset:3072
    ds_read_b128 v[152:155], v197 offset:0
    ds_read_b128 v[156:159], v197 offset:1024
    ds_read_b128 v[160:163], v197 offset:2048
    ds_read_b128 v[164:167], v197 offset:3072
    ds_read_b128 v[168:171], v198 offset:0
    ds_read_b128 v[172:175], v198 offset:1024
    ds_read_b128 v[176:179], v198 offset:2048
    ds_read_b128 v[180:183], v198 offset:3072
    s_waitcnt lgkmcnt(8)
    v_add_f32 v120, v120, v136
    v_add_f32 v121, v121, v137
    v_add_f32 v122, v122, v138
    v_add_f32 v123, v123, v139
    v_add_f32 v124, v124, v140
    v_add_f32 v125, v125, v141
    v_add_f32 v126, v126, v142
    v_add_f32 v127, v127, v143
    v_add_f32 v128, v128, v144
    v_add_f32 v129, v129, v145
    v_add_f32 v130, v130, v146
    v_add_f32 v131, v131, v147
    v_add_f32 v132, v132, v148
    v_add_f32 v133, v133, v149
    v_add_f32 v134, v134, v150
    v_add_f32 v135, v135, v151
    s_waitcnt lgkmcnt(4)
    v_add_f32 v120, v120, v152
    v_add_f32 v121, v121, v153
    v_add_f32 v122, v122, v154
    v_add_f32 v123, v123, v155
    v_add_f32 v124, v124, v156
    v_add_f32 v125, v125, v157
    v_add_f32 v126, v126, v158
    v_add_f32 v127, v127, v159
    v_add_f32 v128, v128, v160
    v_add_f32 v129, v129, v161
    v_add_f32 v130, v130, v162
    v_add_f32 v131, v131, v163
    v_add_f32 v132, v132, v164
    v_add_f32 v133, v133, v165
    v_add_f32 v134, v134, v166
    v_add_f32 v135, v135, v167
    s_waitcnt lgkmcnt(0)
    v_add_f32 v120, v120, v168
    v_add_f32 v121, v121, v169
    v_add_f32 v122, v122, v170
    v_add_f32 v123, v123, v171
    v_add_f32 v124, v124, v172
    v_add_f32 v125, v125, v173
    v_add_f32 v126, v126, v174
    v_add_f32 v127, v127, v175
    v_add_f32 v128, v128, v176
    v_add_f32 v129, v129, v177
    v_add_f32 v130, v130, v178
    v_add_f32 v131, v131, v179
    v_add_f32 v132, v132, v180
    v_add_f32 v133, v133, v181
    v_add_f32 v134, v134, v182
    v_add_f32 v135, v135, v183
    s_waitcnt vmcnt(0)
    v_lshlrev_b32 v192, 16, v184
    v_and_b32 v193, 0xffff0000, v184
    v_add_f32 v120, v120, v192
    v_add_f32 v121, v121, v193
    v_lshlrev_b32 v192, 16, v185
    v_and_b32 v193, 0xffff0000, v185
    v_add_f32 v122, v122, v192
    v_add_f32 v123, v123, v193
    v_lshlrev_b32 v192, 16, v186
    v_and_b32 v193, 0xffff0000, v186
    v_add_f32 v124, v124, v192
    v_add_f32 v125, v125, v193
    v_lshlrev_b32 v192, 16, v187
    v_and_b32 v193, 0xffff0000, v187
    v_add_f32 v126, v126, v192
    v_add_f32 v127, v127, v193
    v_lshlrev_b32 v192, 16, v188
    v_and_b32 v193, 0xffff0000, v188
    v_add_f32 v128, v128, v192
    v_add_f32 v129, v129, v193
    v_lshlrev_b32 v192, 16, v189
    v_and_b32 v193, 0xffff0000, v189
    v_add_f32 v130, v130, v192
    v_add_f32 v131, v131, v193
    v_lshlrev_b32 v192, 16, v190
    v_and_b32 v193, 0xffff0000, v190
    v_add_f32 v132, v132, v192
    v_add_f32 v133, v133, v193
    v_lshlrev_b32 v192, 16, v191
    v_and_b32 v193, 0xffff0000, v191
    v_add_f32 v134, v134, v192
    v_add_f32 v135, v135, v193
    v_mov_b32 v192, 163344
    s_mov_b32 s91, 1600000
L_parallel_sum__softmax_full_mha__glu_gated_swiglu__prompt_kernel_wa:
    ds_read_b32 v193, v192
    s_waitcnt lgkmcnt(0)
    v_cmp_ne_u32 vcc, 4, v193
    s_cbranch_vccz L_parallel_sum__softmax_full_mha__glu_gated_swiglu__prompt_kernel_wa_ok
    s_sub_u32 s91, s91, 1
    s_cbranch_scc1 L_parallel_sum__softmax_full_mha__glu_gated_swiglu__prompt_kernel_wa_ok
    s_sleep 4
    s_branch L_parallel_sum__softmax_full_mha__glu_gated_swiglu__prompt_kernel_wa
L_parallel_sum__softmax_full_mha__glu_gated_swiglu__prompt_kernel_wa_ok:
    s_add_u32 m0, s76, 0
    s_add_u32 s36, s75, 0
    buffer_load_dwordx4 v2, s[16:19], s36 offen lds
    s_add_u32 m0, s76, 1024
    s_add_u32 s36, s75, 7168
    buffer_load_dwordx4 v2, s[16:19], s36 offen lds
    s_add_u32 m0, s76, 2048
    s_add_u32 s36, s75, 14336
    buffer_load_dwordx4 v2, s[16:19], s36 offen lds
    s_add_u32 m0, s76, 3072
    s_add_u32 s36, s75, 21504
    buffer_load_dwordx4 v2, s[16:19], s36 offen lds
    s_add_u32 m0, s76, 4096
    s_add_u32 s36, s75, 28672
    buffer_load_dwordx4 v2, s[16:19], s36 offen lds
    s_add_u32 m0, s76, 5120
    s_add_u32 s36, s75, 35840
    buffer_load_dwordx4 v2, s[16:19], s36 offen lds
    s_add_u32 m0, s76, 6144
    s_add_u32 s36, s75, 43008
    buffer_load_dwordx4 v2, s[16:19], s36 offen lds
    s_add_u32 m0, s76, 7168
    s_add_u32 s36, s75, 50176
    buffer_load_dwordx4 v2, s[16:19], s36 offen lds
    s_add_u32 m0, s76, 8192
    s_add_u32 s36, s75, 57344
    buffer_load_dwordx4 v2, s[16:19], s36 offen lds
    s_add_u32 m0, s76, 9216
    s_add_u32 s36, s75, 64512
    buffer_load_dwordx4 v2, s[16:19], s36 offen lds
    s_add_u32 m0, s76, 10240
    s_add_u32 s36, s75, 71680
    buffer_load_dwordx4 v2, s[16:19], s36 offen lds
    s_add_u32 m0, s76, 11264
    s_add_u32 s36, s75, 78848
    buffer_load_dwordx4 v2, s[16:19], s36 offen lds
    s_add_u32 m0, s76, 12288
    s_add_u32 s36, s75, 86016
    buffer_load_dwordx4 v2, s[16:19], s36 offen lds
    s_add_u32 m0, s76, 13312
    s_add_u32 s36, s75, 93184
    buffer_load_dwordx4 v2, s[16:19], s36 offen lds
    s_add_u32 m0, s76, 14336
    s_add_u32 s36, s75, 100352
    buffer_load_dwordx4 v2, s[16:19], s36 offen lds
    s_mul_i32 s36, s73, 24576
    s_add_u32 s36, s36, 61440
    v_add_u32 v7, s36, v1
    s_xor_b32 s36, s73, 1
    s_mul_i32 s36, s36, 24576
    s_add_u32 s36, s36, 61440
    v_add_u32 v8, s36, v1
    s_cmp_eq_u32 s73, 0
    s_cbranch_scc0 L_parallel_sum__softmax_full_mha__glu_gated_swiglu__prompt_kernel_gob
    s_lshl_b32 s39, s65, 7
    s_add_u32 s39, s39, 0x1202000
    v_lshlrev_b32 v192, 2, v0
    s_mov_b32 exec_lo, -1
    s_mov_b32 exec_hi, 0
    s_mov_b32 s91, 200000
L_parallel_sum__softmax_full_mha__glu_gated_swiglu__prompt_kernel_go:
    buffer_load_dword v193, v192, s[4:7], s39 offen sc1
    s_waitcnt vmcnt(0)
    v_cmp_ne_u32 vcc, 1, v193
    s_cbranch_vccz L_parallel_sum__softmax_full_mha__glu_gated_swiglu__prompt_kernel_go_ok
    s_sub_u32 s91, s91, 1
    s_cbranch_scc1 L_parallel_sum__softmax_full_mha__glu_gated_swiglu__prompt_kernel_go_ok
    s_sleep 2
    s_branch L_parallel_sum__softmax_full_mha__glu_gated_swiglu__prompt_kernel_go
L_parallel_sum__softmax_full_mha__glu_gated_swiglu__prompt_kernel_go_ok:
    s_mov_b64 exec, -1
L_parallel_sum__softmax_full_mha__glu_gated_swiglu__prompt_kernel_gob:
    s_waitcnt vmcnt(0)
    s_barrier
    buffer_load_dwordx4 v[16:19], v1, s[4:7], s70 offen offset:0 sc1
    buffer_load_dwordx4 v[20:23], v1, s[4:7], s70 offen offset:1024 sc1
    buffer_load_dwordx4 v[24:27], v1, s[4:7], s70 offen offset:2048 sc1
    buffer_load_dwordx4 v[28:31], v1, s[4:7], s70 offen offset:3072 sc1
    s_add_u32 s70, s70, 4096
    buffer_load_dwordx4 v[32:35], v1, s[4:7], s70 offen offset:0 sc1
    buffer_load_dwordx4 v[36:39], v1, s[4:7], s70 offen offset:1024 sc1
    buffer_load_dwordx4 v[40:43], v1, s[4:7], s70 offen offset:2048 sc1
    buffer_load_dwordx4 v[44:47], v1, s[4:7], s70 offen offset:3072 sc1
    s_add_u32 s70, s70, 4096
    buffer_load_dwordx4 v[48:51], v1, s[4:7], s70 offen offset:0 sc1
    buffer_load_dwordx4 v[52:55], v1, s[4:7], s70 offen offset:1024 sc1
    buffer_load_dwordx4 v[56:59], v1, s[4:7], s70 offen offset:2048 sc1
    buffer_load_dwordx4 v[60:63], v1, s[4:7], s70 offen offset:3072 sc1
    s_add_u32 s70, s70, 4096
    buffer_load_dwordx4 v[64:67], v1, s[4:7], s70 offen offset:0 sc1
    buffer_load_dwordx4 v[68:71], v1, s[4:7], s70 offen offset:1024 sc1
    buffer_load_dwordx4 v[72:75], v1, s[4:7], s70 offen offset:2048 sc1
    buffer_load_dwordx4 v[76:79], v1, s[4:7], s70 offen offset:3072 sc1
    ds_read_b64_tr_b16 v[104:105], v5 offset:0
    ds_read_b64_tr_b16 v[106:107], v5 offset:1024
    ds_read_b64_tr_b16 v[108:109], v6 offset:0
    ds_read_b64_tr_b16 v[110:111], v6 offset:1024
    ds_read_b64_tr_b16 v[112:113], v5 offset:2048
    ds_read_b64_tr_b16 v[114:115], v5 offset:3072
    ds_read_b64_tr_b16 v[116:117], v6 offset:2048
    ds_read_b64_tr_b16 v[118:119], v6 offset:3072
    s_waitcnt vmcnt(15)
    s_waitcnt lgkmcnt(4)
    v_mfma_f32_32x32x16_bf16 v[120:135], v[104:107], v[16:19], v[120:135]
    v_mfma_f32_32x32x16_bf16 v[136:151], v[108:111], v[16:19], 0
    ds_read_b64_tr_b16 v[104:105], v5 offset:3584
    ds_read_b64_tr_b16 v[106:107], v5 offset:4608
    ds_read_b64_tr_b16 v[108:109], v6 offset:3584
    ds_read_b64_tr_b16 v[110:111], v6 offset:4608
    s_waitcnt vmcnt(14)
    s_waitcnt lgkmcnt(4)
    v_mfma_f32_32x32x16_bf16 v[120:135], v[112:115], v[20:23], v[120:135]
    v_mfma_f32_32x32x16_bf16 v[136:151], v[116:119], v[20:23], v[136:151]
    ds_read_b64_tr_b16 v[112:113], v5 offset:5632
    ds_read_b64_tr_b16 v[114:115], v5 offset:6656
    ds_read_b64_tr_b16 v[116:117], v6 offset:5632
    ds_read_b64_tr_b16 v[118:119], v6 offset:6656
    s_waitcnt vmcnt(13)
    s_waitcnt lgkmcnt(4)
    v_mfma_f32_32x32x16_bf16 v[120:135], v[104:107], v[24:27], v[120:135]
    v_mfma_f32_32x32x16_bf16 v[136:151], v[108:111], v[24:27], v[136:151]
    ds_read_b64_tr_b16 v[104:105], v5 offset:7168
    ds_read_b64_tr_b16 v[106:107], v5 offset:8192
    ds_read_b64_tr_b16 v[108:109], v6 offset:7168
    ds_read_b64_tr_b16 v[110:111], v6 offset:8192
    s_waitcnt vmcnt(12)
    s_waitcnt lgkmcnt(4)
    v_mfma_f32_32x32x16_bf16 v[120:135], v[112:115], v[28:31], v[120:135]
    v_mfma_f32_32x32x16_bf16 v[136:151], v[116:119], v[28:31], v[136:151]
    ds_read_b64_tr_b16 v[112:113], v5 offset:9216
    ds_read_b64_tr_b16 v[114:115], v5 offset:10240
    ds_read_b64_tr_b16 v[116:117], v6 offset:9216
    ds_read_b64_tr_b16 v[118:119], v6 offset:10240
    s_waitcnt vmcnt(11)
    s_waitcnt lgkmcnt(4)
    v_mfma_f32_32x32x16_bf16 v[120:135], v[104:107], v[32:35], v[120:135]
    v_mfma_f32_32x32x16_bf16 v[136:151], v[108:111], v[32:35], v[136:151]
    ds_read_b64_tr_b16 v[104:105], v5 offset:10752
    ds_read_b64_tr_b16 v[106:107], v5 offset:11776
    ds_read_b64_tr_b16 v[108:109], v6 offset:10752
    ds_read_b64_tr_b16 v[110:111], v6 offset:11776
    s_waitcnt vmcnt(10)
    s_waitcnt lgkmcnt(4)
    v_mfma_f32_32x32x16_bf16 v[120:135], v[112:115], v[36:39], v[120:135]
    v_mfma_f32_32x32x16_bf16 v[136:151], v[116:119], v[36:39], v[136:151]
    ds_read_b64_tr_b16 v[112:113], v5 offset:12800
    ds_read_b64_tr_b16 v[114:115], v5 offset:13824
    ds_read_b64_tr_b16 v[116:117], v6 offset:12800
    ds_read_b64_tr_b16 v[118:119], v6 offset:13824
    s_waitcnt vmcnt(9)
    s_waitcnt lgkmcnt(4)
    v_mfma_f32_32x32x16_bf16 v[120:135], v[104:107], v[40:43], v[120:135]
    v_mfma_f32_32x32x16_bf16 v[136:151], v[108:111], v[40:43], v[136:151]
    ds_read_b64_tr_b16 v[104:105], v5 offset:14336
    ds_read_b64_tr_b16 v[106:107], v5 offset:15360
    ds_read_b64_tr_b16 v[108:109], v6 offset:14336
    ds_read_b64_tr_b16 v[110:111], v6 offset:15360
    s_waitcnt vmcnt(8)
    s_waitcnt lgkmcnt(4)
    v_mfma_f32_32x32x16_bf16 v[120:135], v[112:115], v[44:47], v[120:135]
    v_mfma_f32_32x32x16_bf16 v[136:151], v[116:119], v[44:47], v[136:151]
    ds_read_b64_tr_b16 v[112:113], v5 offset:16384
    ds_read_b64_tr_b16 v[114:115], v5 offset:17408
    ds_read_b64_tr_b16 v[116:117], v6 offset:16384
    ds_read_b64_tr_b16 v[118:119], v6 offset:17408
    s_waitcnt vmcnt(7)
    s_waitcnt lgkmcnt(4)
    v_mfma_f32_32x32x16_bf16 v[120:135], v[104:107], v[48:51], v[120:135]
    v_mfma_f32_32x32x16_bf16 v[136:151], v[108:111], v[48:51], v[136:151]
    ds_read_b64_tr_b16 v[104:105], v5 offset:17920
    ds_read_b64_tr_b16 v[106:107], v5 offset:18944
    ds_read_b64_tr_b16 v[108:109], v6 offset:17920
    ds_read_b64_tr_b16 v[110:111], v6 offset:18944
    s_waitcnt vmcnt(6)
    s_waitcnt lgkmcnt(4)
    v_mfma_f32_32x32x16_bf16 v[120:135], v[112:115], v[52:55], v[120:135]
    v_mfma_f32_32x32x16_bf16 v[136:151], v[116:119], v[52:55], v[136:151]
    ds_read_b64_tr_b16 v[112:113], v5 offset:19968
    ds_read_b64_tr_b16 v[114:115], v5 offset:20992
    ds_read_b64_tr_b16 v[116:117], v6 offset:19968
    ds_read_b64_tr_b16 v[118:119], v6 offset:20992
    s_waitcnt vmcnt(5)
    s_waitcnt lgkmcnt(4)
    v_mfma_f32_32x32x16_bf16 v[120:135], v[104:107], v[56:59], v[120:135]
    v_mfma_f32_32x32x16_bf16 v[136:151], v[108:111], v[56:59], v[136:151]
    ds_read_b64_tr_b16 v[104:105], v5 offset:21504
    ds_read_b64_tr_b16 v[106:107], v5 offset:22528
    ds_read_b64_tr_b16 v[108:109], v6 offset:21504
    ds_read_b64_tr_b16 v[110:111], v6 offset:22528
    s_waitcnt vmcnt(4)
    s_waitcnt lgkmcnt(4)
    v_mfma_f32_32x32x16_bf16 v[120:135], v[112:115], v[60:63], v[120:135]
    v_mfma_f32_32x32x16_bf16 v[136:151], v[116:119], v[60:63], v[136:151]
    ds_read_b64_tr_b16 v[112:113], v5 offset:23552
    ds_read_b64_tr_b16 v[114:115], v5 offset:24576
    ds_read_b64_tr_b16 v[116:117], v6 offset:23552
    ds_read_b64_tr_b16 v[118:119], v6 offset:24576
    s_waitcnt vmcnt(3)
    s_waitcnt lgkmcnt(4)
    v_mfma_f32_32x32x16_bf16 v[120:135], v[104:107], v[64:67], v[120:135]
    v_mfma_f32_32x32x16_bf16 v[136:151], v[108:111], v[64:67], v[136:151]
    ds_read_b64_tr_b16 v[104:105], v5 offset:25088
    ds_read_b64_tr_b16 v[106:107], v5 offset:26112
    ds_read_b64_tr_b16 v[108:109], v6 offset:25088
    ds_read_b64_tr_b16 v[110:111], v6 offset:26112
    s_waitcnt vmcnt(2)
    s_waitcnt lgkmcnt(4)
    v_mfma_f32_32x32x16_bf16 v[120:135], v[112:115], v[68:71], v[120:135]
    v_mfma_f32_32x32x16_bf16 v[136:151], v[116:119], v[68:71], v[136:151]
    ds_read_b64_tr_b16 v[112:113], v5 offset:27136
    ds_read_b64_tr_b16 v[114:115], v5 offset:28160
    ds_read_b64_tr_b16 v[116:117], v6 offset:27136
    ds_read_b64_tr_b16 v[118:119], v6 offset:28160
    s_waitcnt vmcnt(1)
    s_waitcnt lgkmcnt(4)
    v_mfma_f32_32x32x16_bf16 v[120:135], v[104:107], v[72:75], v[120:135]
    v_mfma_f32_32x32x16_bf16 v[136:151], v[108:111], v[72:75], v[136:151]
    s_waitcnt vmcnt(0)
    s_waitcnt lgkmcnt(0)
    v_mfma_f32_32x32x16_bf16 v[120:135], v[112:115], v[76:79], v[120:135]
    v_mfma_f32_32x32x16_bf16 v[136:151], v[116:119], v[76:79], v[136:151]
    s_nop 7
    s_nop 3
    ds_write_b128 v7, v[136:139] offset:0
    ds_write_b128 v7, v[140:143] offset:1024
    ds_write_b128 v7, v[144:147] offset:2048
    ds_write_b128 v7, v[148:151] offset:3072
    s_waitcnt lgkmcnt(0)
    s_barrier
    ds_read_b128 v[136:139], v8 offset:0
    ds_read_b128 v[140:143], v8 offset:1024
    ds_read_b128 v[144:147], v8 offset:2048
    ds_read_b128 v[148:151], v8 offset:3072
    s_waitcnt lgkmcnt(3)
    v_add_f32 v120, v120, v136
    v_add_f32 v121, v121, v137
    v_add_f32 v122, v122, v138
    v_add_f32 v123, v123, v139
    s_waitcnt lgkmcnt(2)
    v_add_f32 v124, v124, v140
    v_add_f32 v125, v125, v141
    v_add_f32 v126, v126, v142
    v_add_f32 v127, v127, v143
    s_waitcnt lgkmcnt(1)
    v_add_f32 v128, v128, v144
    v_add_f32 v129, v129, v145
    v_add_f32 v130, v130, v146
    v_add_f32 v131, v131, v147
    s_waitcnt lgkmcnt(0)
    v_add_f32 v132, v132, v148
    v_add_f32 v133, v133, v149
    v_add_f32 v134, v134, v150
    v_add_f32 v135, v135, v151
    v_cvt_pk_bf16_f32 v196, v120, v121
    v_cvt_pk_bf16_f32 v197, v122, v123
    v_cvt_pk_bf16_f32 v198, v124, v125
    v_cvt_pk_bf16_f32 v199, v126, v127
    v_cvt_pk_bf16_f32 v200, v128, v129
    v_cvt_pk_bf16_f32 v201, v130, v131
    v_cvt_pk_bf16_f32 v202, v132, v133
    v_cvt_pk_bf16_f32 v203, v134, v135
    s_nop 1
    v_permlane32_swap_b32 v196, v198
    v_permlane32_swap_b32 v197, v199
    v_permlane32_swap_b32 v200, v202
    v_permlane32_swap_b32 v201, v203
    buffer_store_dwordx4 v[196:199], v10, s[20:23], 0 offen offset:0
    buffer_store_dwordx4 v[200:203], v10, s[20:23], 0 offen offset:32
    s_branch L_parallel_sum__softmax_full_mha__glu_gated_swiglu__prompt_kernel_exit
L_parallel_sum__softmax_full_mha__glu_gated_swiglu__prompt_kernel_helper:
    s_sub_u32 s37, s28, 28
    s_lshl_b32 s37, s37, 3
    s_add_u32 s37, s37, s26
    s_lshl_b32 s37, s37, 6
    v_add_u32 v253, s37, v0
    v_lshlrev_b32 v253, 21, v253
    s_mov_b32 s38, 19922944
    v_cmp_gt_u32 vcc, s38, v253
    s_nop 0
    s_and_saveexec_b64 s[94:95], vcc
    s_cbranch_execz L_parallel_sum__softmax_full_mha__glu_gated_swiglu__prompt_kernel_tw1
    buffer_load_dword v252, v253, s[4:7], 0 offen
L_parallel_sum__softmax_full_mha__glu_gated_swiglu__prompt_kernel_tw1:
    s_mov_b64 exec, -1
    s_cmp_eq_u32 s2, 224
    s_cbranch_scc0 L_parallel_sum__softmax_full_mha__glu_gated_swiglu__prompt_kernel_noclr
    s_cmp_eq_u32 s26, 0
    s_cbranch_scc0 L_parallel_sum__softmax_full_mha__glu_gated_swiglu__prompt_kernel_noclr
    v_lshlrev_b32 v1, 4, v0
    v_mov_b32 v4, 0
    v_mov_b32 v5, 0
    v_mov_b32 v6, 0
    v_mov_b32 v7, 0
    s_mov_b32 s37, 0x1200000
    buffer_store_dwordx4 v[4:7], v1, s[4:7], s37 offen sc1
    s_add_u32 s37, s37, 1024
    buffer_store_dwordx4 v[4:7], v1, s[4:7], s37 offen sc1
    s_add_u32 s37, s37, 1024
    buffer_store_dwordx4 v[4:7], v1, s[4:7], s37 offen sc1
    s_add_u32 s37, s37, 1024
    buffer_store_dwordx4 v[4:7], v1, s[4:7], s37 offen sc1
    s_add_u32 s37, s37, 1024
    buffer_store_dwordx4 v[4:7], v1, s[4:7], s37 offen sc1
    s_add_u32 s37, s37, 1024
    buffer_store_dwordx4 v[4:7], v1, s[4:7], s37 offen sc1
    s_add_u32 s37, s37, 1024
    buffer_store_dwordx4 v[4:7], v1, s[4:7], s37 offen sc1
    s_add_u32 s37, s37, 1024
    buffer_store_dwordx4 v[4:7], v1, s[4:7], s37 offen sc1
    s_add_u32 s37, s37, 1024
    buffer_store_dwordx4 v[4:7], v1, s[4:7], s37 offen sc1
    s_add_u32 s37, s37, 1024
    buffer_store_dwordx4 v[4:7], v1, s[4:7], s37 offen sc1
    s_add_u32 s37, s37, 1024
    buffer_store_dwordx4 v[4:7], v1, s[4:7], s37 offen sc1
    s_add_u32 s37, s37, 1024
    buffer_store_dwordx4 v[4:7], v1, s[4:7], s37 offen sc1
    s_waitcnt vmcnt(0)
    s_mov_b64 exec, 1
    v_mov_b32 v5, 1
    global_store_dword v4, v5, s[24:25] sc1
    s_mov_b64 exec, -1
L_parallel_sum__softmax_full_mha__glu_gated_swiglu__prompt_kernel_noclr:
    s_lshl_b32 s36, s27, 2
    s_sub_u32 s37, s28, 28
    s_add_u32 s36, s36, s37
    s_lshl_b32 s36, s36, 3
    s_add_u32 s36, s36, s26
    v_lshlrev_b32 v2, 7, v0
    v_lshlrev_b32 v3, 8, v0
    s_sub_u32 s37, s36, 0
    s_cmp_lt_u32 s37, 147
    s_cbranch_scc0 L_parallel_sum__softmax_full_mha__glu_gated_swiglu__prompt_kernel_warm0
    s_add_u32 s37, s37, 0
    s_mul_i32 s37, s37, 8192
    s_add_u32 s37, s37, 0
    v_add_u32 v4, s37, v2
    global_load_dword v12, v4, s[42:43]
L_parallel_sum__softmax_full_mha__glu_gated_swiglu__prompt_kernel_warm0:
    s_sub_u32 s37, s36, 147
    s_cmp_lt_u32 s37, 98
    s_cbranch_scc0 L_parallel_sum__softmax_full_mha__glu_gated_swiglu__prompt_kernel_warm1
    s_add_u32 s37, s37, 0
    s_mul_i32 s37, s37, 16384
    s_add_u32 s37, s37, 0
    v_add_u32 v4, s37, v3
    global_load_dword v13, v4, s[48:49]
L_parallel_sum__softmax_full_mha__glu_gated_swiglu__prompt_kernel_warm1:
    s_sub_u32 s37, s36, 245
    s_cmp_lt_u32 s37, 11
    s_cbranch_scc0 L_parallel_sum__softmax_full_mha__glu_gated_swiglu__prompt_kernel_warm2
    s_add_u32 s37, s37, 0
    s_mul_i32 s37, s37, 16384
    s_add_u32 s37, s37, 0
    v_add_u32 v4, s37, v3
    global_load_dword v14, v4, s[50:51]
L_parallel_sum__softmax_full_mha__glu_gated_swiglu__prompt_kernel_warm2:
    s_sub_u32 s37, s36, 0
    s_cmp_lt_u32 s37, 87
    s_cbranch_scc0 L_parallel_sum__softmax_full_mha__glu_gated_swiglu__prompt_kernel_warm3
    s_add_u32 s37, s37, 11
    s_mul_i32 s37, s37, 16384
    s_add_u32 s37, s37, 0
    v_add_u32 v4, s37, v3
    global_load_dword v15, v4, s[50:51]
L_parallel_sum__softmax_full_mha__glu_gated_swiglu__prompt_kernel_warm3:
    s_sub_u32 s37, s36, 87
    s_cmp_lt_u32 s37, 98
    s_cbranch_scc0 L_parallel_sum__softmax_full_mha__glu_gated_swiglu__prompt_kernel_warm4
    s_add_u32 s37, s37, 0
    s_mul_i32 s37, s37, 16384
    s_add_u32 s37, s37, 128
    v_add_u32 v4, s37, v3
    global_load_dword v12, v4, s[48:49]
L_parallel_sum__softmax_full_mha__glu_gated_swiglu__prompt_kernel_warm4:
    s_sub_u32 s37, s36, 185
    s_cmp_lt_u32 s37, 71
    s_cbranch_scc0 L_parallel_sum__softmax_full_mha__glu_gated_swiglu__prompt_kernel_warm5
    s_add_u32 s37, s37, 0
    s_mul_i32 s37, s37, 16384
    s_add_u32 s37, s37, 128
    v_add_u32 v4, s37, v3
    global_load_dword v13, v4, s[50:51]
L_parallel_sum__softmax_full_mha__glu_gated_swiglu__prompt_kernel_warm5:
    s_sub_u32 s37, s36, 0
    s_cmp_lt_u32 s37, 27
    s_cbranch_scc0 L_parallel_sum__softmax_full_mha__glu_gated_swiglu__prompt_kernel_warm6
    s_add_u32 s37, s37, 71
    s_mul_i32 s37, s37, 16384
    s_add_u32 s37, s37, 128
    v_add_u32 v4, s37, v3
    global_load_dword v14, v4, s[50:51]
L_parallel_sum__softmax_full_mha__glu_gated_swiglu__prompt_kernel_warm6:
    s_sub_u32 s37, s36, 27
    s_cmp_lt_u32 s37, 196
    s_cbranch_scc0 L_parallel_sum__softmax_full_mha__glu_gated_swiglu__prompt_kernel_warm7
    s_add_u32 s37, s37, 0
    s_mul_i32 s37, s37, 8192
    s_add_u32 s37, s37, 0
    v_add_u32 v4, s37, v2
    global_load_dword v15, v4, s[52:53]
L_parallel_sum__softmax_full_mha__glu_gated_swiglu__prompt_kernel_warm7:
    s_sub_u32 s37, s36, 223
    s_cmp_lt_u32 s37, 33
    s_cbranch_scc0 L_parallel_sum__softmax_full_mha__glu_gated_swiglu__prompt_kernel_warm8
    s_add_u32 s37, s37, 0
    s_mul_i32 s37, s37, 8192
    s_add_u32 s37, s37, 0
    v_add_u32 v4, s37, v2
    global_load_dword v12, v4, s[44:45]
L_parallel_sum__softmax_full_mha__glu_gated_swiglu__prompt_kernel_warm8:
    s_sub_u32 s37, s36, 0
    s_cmp_lt_u32 s37, 16
    s_cbranch_scc0 L_parallel_sum__softmax_full_mha__glu_gated_swiglu__prompt_kernel_warm9
    s_add_u32 s37, s37, 33
    s_mul_i32 s37, s37, 8192
    s_add_u32 s37, s37, 0
    v_add_u32 v4, s37, v2
    global_load_dword v13, v4, s[44:45]
L_parallel_sum__softmax_full_mha__glu_gated_swiglu__prompt_kernel_warm9:
    s_cmp_ge_u32 s26, 4
    s_cbranch_scc1 L_parallel_sum__softmax_full_mha__glu_gated_swiglu__prompt_kernel_exit
    s_cmp_eq_u32 s26, 0
    s_cbranch_scc0 L_parallel_sum__softmax_full_mha__glu_gated_swiglu__prompt_kernel_hwait
    v_mov_b32 v3, 163328
    v_mov_b32 v4, 0
    v_mov_b32 v5, 0
    v_mov_b32 v6, 0
    v_mov_b32 v7, 0
    ds_write_b128 v3, v[4:7]
    ds_write_b128 v3, v[4:7] offset:16
    v_mov_b32 v208, 0
    s_mov_b32 s91, 200000
L_parallel_sum__softmax_full_mha__glu_gated_swiglu__prompt_kernel_hclr:
    global_load_dword v209, v208, s[24:25] sc1
    s_waitcnt vmcnt(0)
    v_cmp_gt_u32 vcc, 1, v209
    s_cbranch_vccz L_parallel_sum__softmax_full_mha__glu_gated_swiglu__prompt_kernel_hclr_ok
    s_sub_u32 s91, s91, 1
    s_cbranch_scc1 L_parallel_sum__softmax_full_mha__glu_gated_swiglu__prompt_kernel_hclr_ok
    s_sleep 16
    s_branch L_parallel_sum__softmax_full_mha__glu_gated_swiglu__prompt_kernel_hclr
L_parallel_sum__softmax_full_mha__glu_gated_swiglu__prompt_kernel_hclr_ok:
    v_lshlrev_b32 v212, 4, v0
    s_mov_b32 s39, 0x1200000
    s_mov_b32 exec_lo, -1
    s_mov_b32 exec_hi, 0x00ffffff
    s_mov_b32 s91, 200000
L_parallel_sum__softmax_full_mha__glu_gated_swiglu__prompt_kernel_hq:
    buffer_load_dwordx4 v[208:211], v212, s[4:7], s39 offen sc1
    s_waitcnt vmcnt(0)
    v_and_b32 v208, v208, v209
    v_and_b32 v210, v210, v211
    v_and_b32 v208, v208, v210
    v_cmp_ne_u32 vcc, 1, v208
    s_cbranch_vccz L_parallel_sum__softmax_full_mha__glu_gated_swiglu__prompt_kernel_hq_ok
    s_sub_u32 s91, s91, 1
    s_cbranch_scc1 L_parallel_sum__softmax_full_mha__glu_gated_swiglu__prompt_kernel_hq_ok
    s_sleep 32
    s_branch L_parallel_sum__softmax_full_mha__glu_gated_swiglu__prompt_kernel_hq
L_parallel_sum__softmax_full_mha__glu_gated_swiglu__prompt_kernel_hq_ok:
    s_mov_b64 exec, -1
    s_waitcnt lgkmcnt(0)
L_parallel_sum__softmax_full_mha__glu_gated_swiglu__prompt_kernel_hwait:
    s_barrier
    s_and_b32 s37, s28, 1
    s_lshl_b32 s60, s27, 1
    s_add_u32 s60, s60, s37
    s_lshr_b32 s61, s28, 1
    s_mul_i32 s62, s27, 7
    s_mul_i32 s38, s37, 3
    s_add_u32 s62, s62, s38
    v_lshlrev_b32 v1, 4, v0
    s_mov_b32 s92, 0x0fffffff
    s_mov_b32 s93, 0x0fffffff
    s_lshl_b32 s36, s61, 2
    s_mul_i32 s36, s36, 28672
    s_lshl_b32 s37, s62, 9
    s_add_u32 s36, s36, s37
    s_add_u32 s38, s36, 0x700000
    s_add_u32 s36, s26, 0
    s_and_b32 s36, s36, 3
    s_mul_i32 s36, s36, 28672
    s_add_u32 s80, s36, s38
    s_add_u32 s36, s26, 1
    s_and_b32 s36, s36, 3
    s_mul_i32 s36, s36, 28672
    s_add_u32 s81, s36, s38
    s_add_u32 s36, s26, 2
    s_and_b32 s36, s36, 3
    s_mul_i32 s36, s36, 28672
    s_add_u32 s82, s36, s38
    s_add_u32 s36, s26, 3
    s_and_b32 s36, s36, 3
    s_mul_i32 s36, s36, 28672
    s_add_u32 s87, s36, s38
    buffer_load_dwordx4 v[16:19], v1, s[4:7], s80 offen offset:0 sc1
    buffer_load_dwordx4 v[20:23], v1, s[4:7], s80 offen offset:1024 sc1
    s_mul_i32 s65, s26, 458752
    s_add_u32 s66, s65, 458752
    s_and_b32 s36, s61, 3
    s_mul_i32 s36, s36, 114688
    s_add_u32 s76, s36, s65
    s_add_u32 s77, s76, 28672
    s_add_u32 s78, s76, 57344
    s_add_u32 s79, s76, 86016
    s_lshl_b32 s37, s62, 9
    s_add_u32 s37, s37, 0x8c0000
    v_add_u32 v8, s37, v1
    buffer_load_dwordx4 v[48:51], v8, s[4:7], s76 offen offset:0 sc1
    buffer_load_dwordx4 v[52:55], v8, s[4:7], s76 offen offset:1024 sc1
    v_and_b32 v4, 31, v0
    v_lshrrev_b32 v5, 5, v0
    s_mul_i32 s37, s60, 28
    v_add_u32 v6, s37, v4
    v_lshlrev_b32 v6, 4, v6
    v_mul_u32_u24 v7, 7168, v5
    v_add_u32 v2, v6, v7
    v_add_u32 v2, 0xa80000, v2
    v_add_u32 v3, 14336, v2
    v_cmp_eq_u32 vcc, 28, v4
    v_mov_b32 v9, 0x3f803f80
    s_nop 0
    v_cndmask_b32 v9, 0, v9, vcc
    v_mov_b32 v64, v9
    v_mov_b32 v65, v9
    v_mov_b32 v66, v9
    v_mov_b32 v67, v9
    v_mov_b32 v68, v9
    v_mov_b32 v69, v9
    v_mov_b32 v70, v9
    v_mov_b32 v71, v9
    v_mov_b32 v72, v9
    v_mov_b32 v73, v9
    v_mov_b32 v74, v9
    v_mov_b32 v75, v9
    v_mov_b32 v76, v9
    v_mov_b32 v77, v9
    v_mov_b32 v78, v9
    v_mov_b32 v79, v9
    s_mov_b64 exec, s[92:93]
    buffer_load_dwordx4 v[64:67], v2, s[4:7], s76 offen sc1
    buffer_load_dwordx4 v[68:71], v3, s[4:7], s76 offen sc1
    s_mov_b64 exec, -1
    buffer_load_dwordx4 v[24:27], v1, s[4:7], s81 offen offset:0 sc1
    buffer_load_dwordx4 v[28:31], v1, s[4:7], s81 offen offset:1024 sc1
    buffer_load_dwordx4 v[32:35], v1, s[4:7], s82 offen offset:0 sc1
    buffer_load_dwordx4 v[36:39], v1, s[4:7], s82 offen offset:1024 sc1
    buffer_load_dwordx4 v[40:43], v1, s[4:7], s87 offen offset:0 sc1
    buffer_load_dwordx4 v[44:47], v1, s[4:7], s87 offen offset:1024 sc1
    buffer_load_dword v10, v1, s[4:7], s80 offen
    buffer_load_dwordx4 v[56:59], v8, s[4:7], s77 offen offset:0 sc1
    buffer_load_dwordx4 v[60:63], v8, s[4:7], s77 offen offset:1024 sc1
    s_mov_b64 exec, s[92:93]
    buffer_load_dwordx4 v[72:75], v2, s[4:7], s77 offen sc1
    buffer_load_dwordx4 v[76:79], v3, s[4:7], s77 offen sc1
    s_mov_b64 exec, -1
    buffer_load_dword v11, v1, s[4:7], s80 offen
    s_mov_b32 s63, 0
L_parallel_sum__softmax_full_mha__glu_gated_swiglu__prompt_kernel_attn:
    s_setprio 3
    s_add_u32 s67, s76, 114688
    s_cmp_eq_u32 s67, s66
    s_cselect_b32 s67, s65, s67
    s_add_u32 s68, s67, 28672
    s_add_u32 s69, s67, 57344
    s_add_u32 s70, s67, 86016
    s_add_u32 s71, s67, 114688
    s_cmp_eq_u32 s71, s66
    s_cselect_b32 s71, s65, s71
    s_add_u32 s72, s71, 28672
    s_add_u32 s73, s71, 57344
    s_add_u32 s74, s71, 86016
    s_add_u32 s75, s71, 114688
    s_cmp_eq_u32 s75, s66
    s_cselect_b32 s75, s65, s75
    s_add_u32 s88, s75, 28672
    s_add_u32 s89, s75, 57344
    s_add_u32 s90, s75, 86016
    s_add_u32 s36, s26, 1
    s_and_b32 s36, s36, 3
    s_mul_i32 s36, s36, 12288
    s_add_u32 s36, s36, 0
    v_add_u32 v4, s36, v1
    s_add_u32 s36, s26, 2
    s_and_b32 s36, s36, 3
    s_mul_i32 s36, s36, 12288
    s_add_u32 s36, s36, 4096
    v_add_u32 v5, s36, v1
    s_add_u32 s36, s26, 3
    s_and_b32 s36, s36, 3
    s_mul_i32 s36, s36, 12288
    s_add_u32 s36, s36, 8192
    v_add_u32 v6, s36, v1
    s_mul_i32 s36, s26, 12288
    s_add_u32 s36, s36, 0
    v_add_u32 v7, s36, v1
    s_lshl_b32 s36, s61, 2
    s_add_u32 s36, s36, s26
    s_lshl_b32 s36, s36, 4
    s_add_u32 s36, s36, s60
    s_lshl_b32 s64, s36, 11
    s_add_u32 s64, s64, 0xc40000
    s_lshl_b32 s83, s36, 2
    s_add_u32 s83, s83, 0x1202000
    s_mov_b32 s84, 0x2b800000
    s_mov_b32 s85, 0x67800000
    s_mov_b32 s86, 0x7b800000
    v_mov_b32 v12, 163340
    v_mov_b32 v13, 1
    v_mov_b32 v14, 163344
    s_waitcnt vmcnt(6)
    s_and_b32 s36, s60, 1
    s_cmp_eq_u32 s36, 0
    s_cbranch_scc0 L_parallel_sum__softmax_full_mha__glu_gated_swiglu__prompt_kernel_odd
    s_mov_b32 exec_lo, 0
    v_mov_b32 v22, 0
    v_mov_b32 v23, 0
    v_mov_b32 v30, 0
    v_mov_b32 v31, 0
    v_mov_b32 v38, 0
    v_mov_b32 v39, 0
    v_mov_b32 v46, 0
    v_mov_b32 v47, 0
    s_branch L_parallel_sum__softmax_full_mha__glu_gated_swiglu__prompt_kernel_qz
L_parallel_sum__softmax_full_mha__glu_gated_swiglu__prompt_kernel_odd:
    s_mov_b32 exec_hi, 0
    v_mov_b32 v16, 0
    v_mov_b32 v17, 0
    v_mov_b32 v24, 0
    v_mov_b32 v25, 0
    v_mov_b32 v32, 0
    v_mov_b32 v33, 0
    v_mov_b32 v40, 0
    v_mov_b32 v41, 0
L_parallel_sum__softmax_full_mha__glu_gated_swiglu__prompt_kernel_qz:
    s_mov_b64 exec, -1
    s_nop 1
    v_mfma_f32_32x32x16_bf16 v[176:191], v[48:51], v[16:19], 0
    v_mfma_f32_32x32x16_bf16 v[176:191], v[52:55], v[20:23], v[176:191]
    v_mov_b32 v232, v9
    v_mov_b32 v233, v9
    v_mov_b32 v234, v9
    v_mov_b32 v235, v9
    v_mov_b32 v236, v9
    v_mov_b32 v237, v9
    v_mov_b32 v238, v9
    v_mov_b32 v239, v9
    v_mov_b32 v240, v9
    v_mov_b32 v241, v9
    v_mov_b32 v242, v9
    v_mov_b32 v243, v9
    v_mov_b32 v244, v9
    v_mov_b32 v245, v9
    v_mov_b32 v246, v9
    v_mov_b32 v247, v9
    buffer_load_dwordx4 v[144:147], v8, s[4:7], s78 offen offset:0 sc1
    buffer_load_dwordx4 v[148:151], v8, s[4:7], s78 offen offset:1024 sc1
    s_mov_b64 exec, s[92:93]
    buffer_load_dwordx4 v[232:235], v2, s[4:7], s78 offen sc1
    buffer_load_dwordx4 v[236:239], v3, s[4:7], s78 offen sc1
    s_mov_b64 exec, -1
    buffer_load_dwordx4 v[152:155], v8, s[4:7], s79 offen offset:0 sc1
    buffer_load_dwordx4 v[156:159], v8, s[4:7], s79 offen offset:1024 sc1
    s_mov_b32 s91, 3
    v_mfma_f32_32x32x16_bf16 v[192:207], v[48:51], v[24:27], 0
    v_exp_f32 v176, v176
    v_exp_f32 v177, v177
    v_exp_f32 v178, v178
    v_exp_f32 v179, v179
    v_exp_f32 v180, v180
    v_exp_f32 v181, v181
    v_mfma_f32_32x32x16_bf16 v[192:207], v[52:55], v[28:31], v[192:207]
    v_exp_f32 v182, v182
    v_exp_f32 v183, v183
    v_exp_f32 v184, v184
    v_exp_f32 v185, v185
    v_exp_f32 v186, v186
    v_exp_f32 v187, v187
    v_exp_f32 v188, v188
    v_exp_f32 v189, v189
    v_exp_f32 v190, v190
    v_exp_f32 v191, v191
    v_cvt_pk_bf16_f32 v128, v176, v177
    v_cvt_pk_bf16_f32 v129, v178, v179
    v_cvt_pk_bf16_f32 v130, v180, v181
    v_cvt_pk_bf16_f32 v131, v182, v183
    v_cvt_pk_bf16_f32 v132, v184, v185
    v_cvt_pk_bf16_f32 v133, v186, v187
    v_cvt_pk_bf16_f32 v134, v188, v189
    v_cvt_pk_bf16_f32 v135, v190, v191
    s_mov_b64 exec, s[92:93]
    buffer_load_dwordx4 v[240:243], v2, s[4:7], s79 offen sc1
    buffer_load_dwordx4 v[244:247], v3, s[4:7], s79 offen sc1
    s_mov_b64 exec, -1
    v_mfma_f32_32x32x16_bf16 v[176:191], v[48:51], v[32:35], 0
    v_exp_f32 v192, v192
    v_exp_f32 v193, v193
    v_exp_f32 v194, v194
    v_mfma_f32_32x32x16_bf16 v[80:95], v[64:67], v[128:131], 0
    v_exp_f32 v195, v195
    v_exp_f32 v196, v196
    v_exp_f32 v197, v197
    v_mfma_f32_32x32x16_bf16 v[176:191], v[52:55], v[36:39], v[176:191]
    v_exp_f32 v198, v198
    v_exp_f32 v199, v199
    v_exp_f32 v200, v200
    v_mfma_f32_32x32x16_bf16 v[80:95], v[68:71], v[132:135], v[80:95]
    v_exp_f32 v201, v201
    v_exp_f32 v202, v202
    v_exp_f32 v203, v203
    v_exp_f32 v204, v204
    v_exp_f32 v205, v205
    v_exp_f32 v206, v206
    v_exp_f32 v207, v207
    v_cvt_pk_bf16_f32 v136, v192, v193
    v_cvt_pk_bf16_f32 v137, v194, v195
    v_cvt_pk_bf16_f32 v138, v196, v197
    v_cvt_pk_bf16_f32 v139, v198, v199
    v_cvt_pk_bf16_f32 v140, v200, v201
    v_cvt_pk_bf16_f32 v141, v202, v203
    v_cvt_pk_bf16_f32 v142, v204, v205
    v_cvt_pk_bf16_f32 v143, v206, v207
    v_mfma_f32_32x32x16_bf16 v[192:207], v[48:51], v[40:43], 0
    v_exp_f32 v176, v176
    v_exp_f32 v177, v177
    v_exp_f32 v178, v178
    v_mfma_f32_32x32x16_bf16 v[96:111], v[64:67], v[136:139], 0
    v_exp_f32 v179, v179
    v_exp_f32 v180, v180
    v_exp_f32 v181, v181
    v_mfma_f32_32x32x16_bf16 v[192:207], v[52:55], v[44:47], v[192:207]
    v_exp_f32 v182, v182
    v_exp_f32 v183, v183
    v_exp_f32 v184, v184
    v_mfma_f32_32x32x16_bf16 v[96:111], v[68:71], v[140:143], v[96:111]
    v_exp_f32 v185, v185
    v_exp_f32 v186, v186
    v_exp_f32 v187, v187
    v_exp_f32 v188, v188
    v_exp_f32 v189, v189
    v_exp_f32 v190, v190
    v_exp_f32 v191, v191
    v_cvt_pk_bf16_f32 v128, v176, v177
    v_cvt_pk_bf16_f32 v129, v178, v179
    v_cvt_pk_bf16_f32 v130, v180, v181
    v_cvt_pk_bf16_f32 v131, v182, v183
    v_cvt_pk_bf16_f32 v132, v184, v185
    v_cvt_pk_bf16_f32 v133, v186, v187
    v_cvt_pk_bf16_f32 v134, v188, v189
    v_cvt_pk_bf16_f32 v135, v190, v191
    buffer_load_dwordx4 v[48:51], v8, s[4:7], s67 offen offset:0 sc1
    buffer_load_dwordx4 v[52:55], v8, s[4:7], s67 offen offset:1024 sc1
    s_waitcnt vmcnt(10)
    s_cmp_eq_u32 s63, 1
    s_cbranch_scc0 L_parallel_sum__softmax_full_mha__glu_gated_swiglu__prompt_kernel_nh
    s_mov_b32 s63, 0
    v_mov_b32 v208, 163328
    v_mov_b32 v209, 1
    s_mov_b64 exec, 1
    ds_add_rtn_u32 v209, v208, v209
    s_waitcnt lgkmcnt(0)
    v_cmp_eq_u32 vcc, 7, v209
    s_cbranch_vccz L_parallel_sum__softmax_full_mha__glu_gated_swiglu__prompt_kernel_hda
    s_lshl_b32 s37, s29, 4
    s_add_u32 s37, s37, s30
    s_lshl_b32 s37, s37, 2
    s_add_u32 s37, s37, 0x1201000
    v_mov_b32 v208, 0
    v_mov_b32 v209, 1
    buffer_store_dword v209, v208, s[4:7], s37 offen sc1
L_parallel_sum__softmax_full_mha__glu_gated_swiglu__prompt_kernel_hda:
    s_mov_b64 exec, -1
L_parallel_sum__softmax_full_mha__glu_gated_swiglu__prompt_kernel_nh:
    v_mfma_f32_32x32x16_bf16 v[176:191], v[56:59], v[16:19], 0
    v_exp_f32 v192, v192
    v_exp_f32 v193, v193
    v_exp_f32 v194, v194
    v_mfma_f32_32x32x16_bf16 v[112:127], v[64:67], v[128:131], 0
    v_exp_f32 v195, v195
    v_exp_f32 v196, v196
    v_exp_f32 v197, v197
    v_mfma_f32_32x32x16_bf16 v[176:191], v[60:63], v[20:23], v[176:191]
    v_exp_f32 v198, v198
    v_exp_f32 v199, v199
    v_exp_f32 v200, v200
    v_mfma_f32_32x32x16_bf16 v[112:127], v[68:71], v[132:135], v[112:127]
    v_exp_f32 v201, v201
    v_exp_f32 v202, v202
    v_exp_f32 v203, v203
    v_exp_f32 v204, v204
    v_exp_f32 v205, v205
    v_exp_f32 v206, v206
    v_exp_f32 v207, v207
    v_cvt_pk_bf16_f32 v136, v192, v193
    v_cvt_pk_bf16_f32 v137, v194, v195
    v_cvt_pk_bf16_f32 v138, v196, v197
    v_cvt_pk_bf16_f32 v139, v198, v199
    v_cvt_pk_bf16_f32 v140, v200, v201
    v_cvt_pk_bf16_f32 v141, v202, v203
    v_cvt_pk_bf16_f32 v142, v204, v205
    v_cvt_pk_bf16_f32 v143, v206, v207
    v_mfma_f32_32x32x16_bf16 v[192:207], v[56:59], v[24:27], 0
    v_exp_f32 v176, v176
    v_exp_f32 v177, v177
    v_exp_f32 v178, v178
    v_mfma_f32_32x32x16_bf16 v[160:175], v[64:67], v[136:139], 0
    v_exp_f32 v179, v179
    v_exp_f32 v180, v180
    v_exp_f32 v181, v181
    v_mfma_f32_32x32x16_bf16 v[192:207], v[60:63], v[28:31], v[192:207]
    v_exp_f32 v182, v182
    v_exp_f32 v183, v183
    v_exp_f32 v184, v184
    v_mfma_f32_32x32x16_bf16 v[160:175], v[68:71], v[140:143], v[160:175]
    v_exp_f32 v185, v185
    v_exp_f32 v186, v186
    v_exp_f32 v187, v187
    v_exp_f32 v188, v188
    v_exp_f32 v189, v189
    v_exp_f32 v190, v190
    v_exp_f32 v191, v191
    v_cvt_pk_bf16_f32 v128, v176, v177
    v_cvt_pk_bf16_f32 v129, v178, v179
    v_cvt_pk_bf16_f32 v130, v180, v181
    v_cvt_pk_bf16_f32 v131, v182, v183
    v_cvt_pk_bf16_f32 v132, v184, v185
    v_cvt_pk_bf16_f32 v133, v186, v187
    v_cvt_pk_bf16_f32 v134, v188, v189
    v_cvt_pk_bf16_f32 v135, v190, v191
    s_mov_b64 exec, s[92:93]
    buffer_load_dwordx4 v[64:67], v2, s[4:7], s67 offen sc1
    buffer_load_dwordx4 v[68:71], v3, s[4:7], s67 offen sc1
    s_mov_b64 exec, -1
    v_mfma_f32_32x32x16_bf16 v[176:191], v[56:59], v[32:35], 0
    v_exp_f32 v192, v192
    v_exp_f32 v193, v193
    v_exp_f32 v194, v194
    v_mfma_f32_32x32x16_bf16 v[80:95], v[72:75], v[128:131], v[80:95]
    v_exp_f32 v195, v195
    v_exp_f32 v196, v196
    v_exp_f32 v197, v197
    v_mfma_f32_32x32x16_bf16 v[176:191], v[60:63], v[36:39], v[176:191]
    v_exp_f32 v198, v198
    v_exp_f32 v199, v199
    v_exp_f32 v200, v200
    v_mfma_f32_32x32x16_bf16 v[80:95], v[76:79], v[132:135], v[80:95]
    v_exp_f32 v201, v201
    v_exp_f32 v202, v202
    v_exp_f32 v203, v203
    v_exp_f32 v204, v204
    v_exp_f32 v205, v205
    v_exp_f32 v206, v206
    v_exp_f32 v207, v207
    v_cvt_pk_bf16_f32 v136, v192, v193
    v_cvt_pk_bf16_f32 v137, v194, v195
    v_cvt_pk_bf16_f32 v138, v196, v197
    v_cvt_pk_bf16_f32 v139, v198, v199
    v_cvt_pk_bf16_f32 v140, v200, v201
    v_cvt_pk_bf16_f32 v141, v202, v203
    v_cvt_pk_bf16_f32 v142, v204, v205
    v_cvt_pk_bf16_f32 v143, v206, v207
    v_mfma_f32_32x32x16_bf16 v[192:207], v[56:59], v[40:43], 0
    v_exp_f32 v176, v176
    v_exp_f32 v177, v177
    v_exp_f32 v178, v178
    v_mfma_f32_32x32x16_bf16 v[96:111], v[72:75], v[136:139], v[96:111]
    v_exp_f32 v179, v179
    v_exp_f32 v180, v180
    v_exp_f32 v181, v181
    v_mfma_f32_32x32x16_bf16 v[192:207], v[60:63], v[44:47], v[192:207]
    v_exp_f32 v182, v182
    v_exp_f32 v183, v183
    v_exp_f32 v184, v184
    v_mfma_f32_32x32x16_bf16 v[96:111], v[76:79], v[140:143], v[96:111]
    v_exp_f32 v185, v185
    v_exp_f32 v186, v186
    v_exp_f32 v187, v187
    v_exp_f32 v188, v188
    v_exp_f32 v189, v189
    v_exp_f32 v190, v190
    v_exp_f32 v191, v191
    v_cvt_pk_bf16_f32 v128, v176, v177
    v_cvt_pk_bf16_f32 v129, v178, v179
    v_cvt_pk_bf16_f32 v130, v180, v181
    v_cvt_pk_bf16_f32 v131, v182, v183
    v_cvt_pk_bf16_f32 v132, v184, v185
    v_cvt_pk_bf16_f32 v133, v186, v187
    v_cvt_pk_bf16_f32 v134, v188, v189
    v_cvt_pk_bf16_f32 v135, v190, v191
    buffer_load_dwordx4 v[56:59], v8, s[4:7], s68 offen offset:0 sc1
    buffer_load_dwordx4 v[60:63], v8, s[4:7], s68 offen offset:1024 sc1
    s_waitcnt vmcnt(10)
    v_mfma_f32_32x32x16_bf16 v[176:191], v[144:147], v[16:19], 0
    v_exp_f32 v192, v192
    v_exp_f32 v193, v193
    v_exp_f32 v194, v194
    v_mfma_f32_32x32x16_bf16 v[112:127], v[72:75], v[128:131], v[112:127]
    v_exp_f32 v195, v195
    v_exp_f32 v196, v196
    v_exp_f32 v197, v197
    v_mfma_f32_32x32x16_bf16 v[176:191], v[148:151], v[20:23], v[176:191]
    v_exp_f32 v198, v198
    v_exp_f32 v199, v199
    v_exp_f32 v200, v200
    v_mfma_f32_32x32x16_bf16 v[112:127], v[76:79], v[132:135], v[112:127]
    v_exp_f32 v201, v201
    v_exp_f32 v202, v202
    v_exp_f32 v203, v203
    v_exp_f32 v204, v204
    v_exp_f32 v205, v205
    v_exp_f32 v206, v206
    v_exp_f32 v207, v207
    v_cvt_pk_bf16_f32 v136, v192, v193
    v_cvt_pk_bf16_f32 v137, v194, v195
    v_cvt_pk_bf16_f32 v138, v196, v197
    v_cvt_pk_bf16_f32 v139, v198, v199
    v_cvt_pk_bf16_f32 v140, v200, v201
    v_cvt_pk_bf16_f32 v141, v202, v203
    v_cvt_pk_bf16_f32 v142, v204, v205
    v_cvt_pk_bf16_f32 v143, v206, v207
    v_mfma_f32_32x32x16_bf16 v[192:207], v[144:147], v[24:27], 0
    v_exp_f32 v176, v176
    v_exp_f32 v177, v177
    v_exp_f32 v178, v178
    v_mfma_f32_32x32x16_bf16 v[160:175], v[72:75], v[136:139], v[160:175]
    v_exp_f32 v179, v179
    v_exp_f32 v180, v180
    v_exp_f32 v181, v181
    v_mfma_f32_32x32x16_bf16 v[192:207], v[148:151], v[28:31], v[192:207]
    v_exp_f32 v182, v182
    v_exp_f32 v183, v183
    v_exp_f32 v184, v184
    v_mfma_f32_32x32x16_bf16 v[160:175], v[76:79], v[140:143], v[160:175]
    v_exp_f32 v185, v185
    v_exp_f32 v186, v186
    v_exp_f32 v187, v187
    v_exp_f32 v188, v188
    v_exp_f32 v189, v189
    v_exp_f32 v190, v190
    v_exp_f32 v191, v191
    v_cvt_pk_bf16_f32 v128, v176, v177
    v_cvt_pk_bf16_f32 v129, v178, v179
    v_cvt_pk_bf16_f32 v130, v180, v181
    v_cvt_pk_bf16_f32 v131, v182, v183
    v_cvt_pk_bf16_f32 v132, v184, v185
    v_cvt_pk_bf16_f32 v133, v186, v187
    v_cvt_pk_bf16_f32 v134, v188, v189
    v_cvt_pk_bf16_f32 v135, v190, v191
    s_mov_b64 exec, s[92:93]
    buffer_load_dwordx4 v[72:75], v2, s[4:7], s68 offen sc1
    buffer_load_dwordx4 v[76:79], v3, s[4:7], s68 offen sc1
    s_mov_b64 exec, -1
    v_mfma_f32_32x32x16_bf16 v[176:191], v[144:147], v[32:35], 0
    v_exp_f32 v192, v192
    v_exp_f32 v193, v193
    v_exp_f32 v194, v194
    v_mfma_f32_32x32x16_bf16 v[80:95], v[232:235], v[128:131], v[80:95]
    v_exp_f32 v195, v195
    v_exp_f32 v196, v196
    v_exp_f32 v197, v197
    v_mfma_f32_32x32x16_bf16 v[176:191], v[148:151], v[36:39], v[176:191]
    v_exp_f32 v198, v198
    v_exp_f32 v199, v199
    v_exp_f32 v200, v200
    v_mfma_f32_32x32x16_bf16 v[80:95], v[236:239], v[132:135], v[80:95]
    v_exp_f32 v201, v201
    v_exp_f32 v202, v202
    v_exp_f32 v203, v203
    v_exp_f32 v204, v204
    v_exp_f32 v205, v205
    v_exp_f32 v206, v206
    v_exp_f32 v207, v207
    v_cvt_pk_bf16_f32 v136, v192, v193
    v_cvt_pk_bf16_f32 v137, v194, v195
    v_cvt_pk_bf16_f32 v138, v196, v197
    v_cvt_pk_bf16_f32 v139, v198, v199
    v_cvt_pk_bf16_f32 v140, v200, v201
    v_cvt_pk_bf16_f32 v141, v202, v203
    v_cvt_pk_bf16_f32 v142, v204, v205
    v_cvt_pk_bf16_f32 v143, v206, v207
    v_mfma_f32_32x32x16_bf16 v[192:207], v[144:147], v[40:43], 0
    v_exp_f32 v176, v176
    v_exp_f32 v177, v177
    v_exp_f32 v178, v178
    v_mfma_f32_32x32x16_bf16 v[96:111], v[232:235], v[136:139], v[96:111]
    v_exp_f32 v179, v179
    v_exp_f32 v180, v180
    v_exp_f32 v181, v181
    v_mfma_f32_32x32x16_bf16 v[192:207], v[148:151], v[44:47], v[192:207]
    v_exp_f32 v182, v182
    v_exp_f32 v183, v183
    v_exp_f32 v184, v184
    v_mfma_f32_32x32x16_bf16 v[96:111], v[236:239], v[140:143], v[96:111]
    v_exp_f32 v185, v185
    v_exp_f32 v186, v186
    v_exp_f32 v187, v187
    v_exp_f32 v188, v188
    v_exp_f32 v189, v189
    v_exp_f32 v190, v190
    v_exp_f32 v191, v191
    v_cvt_pk_bf16_f32 v128, v176, v177
    v_cvt_pk_bf16_f32 v129, v178, v179
    v_cvt_pk_bf16_f32 v130, v180, v181
    v_cvt_pk_bf16_f32 v131, v182, v183
    v_cvt_pk_bf16_f32 v132, v184, v185
    v_cvt_pk_bf16_f32 v133, v186, v187
    v_cvt_pk_bf16_f32 v134, v188, v189
    v_cvt_pk_bf16_f32 v135, v190, v191
    buffer_load_dwordx4 v[144:147], v8, s[4:7], s69 offen offset:0 sc1
    buffer_load_dwordx4 v[148:151], v8, s[4:7], s69 offen offset:1024 sc1
    s_waitcnt vmcnt(10)
    v_mfma_f32_32x32x16_bf16 v[176:191], v[152:155], v[16:19], 0
    v_exp_f32 v192, v192
    v_exp_f32 v193, v193
    v_exp_f32 v194, v194
    v_mfma_f32_32x32x16_bf16 v[112:127], v[232:235], v[128:131], v[112:127]
    v_exp_f32 v195, v195
    v_exp_f32 v196, v196
    v_exp_f32 v197, v197
    v_mfma_f32_32x32x16_bf16 v[176:191], v[156:159], v[20:23], v[176:191]
    v_exp_f32 v198, v198
    v_exp_f32 v199, v199
    v_exp_f32 v200, v200
    v_mfma_f32_32x32x16_bf16 v[112:127], v[236:239], v[132:135], v[112:127]
    v_exp_f32 v201, v201
    v_exp_f32 v202, v202
    v_exp_f32 v203, v203
    v_exp_f32 v204, v204
    v_exp_f32 v205, v205
    v_exp_f32 v206, v206
    v_exp_f32 v207, v207
    v_cvt_pk_bf16_f32 v136, v192, v193
    v_cvt_pk_bf16_f32 v137, v194, v195
    v_cvt_pk_bf16_f32 v138, v196, v197
    v_cvt_pk_bf16_f32 v139, v198, v199
    v_cvt_pk_bf16_f32 v140, v200, v201
    v_cvt_pk_bf16_f32 v141, v202, v203
    v_cvt_pk_bf16_f32 v142, v204, v205
    v_cvt_pk_bf16_f32 v143, v206, v207
    v_mfma_f32_32x32x16_bf16 v[192:207], v[152:155], v[24:27], 0
    v_exp_f32 v176, v176
    v_exp_f32 v177, v177
    v_exp_f32 v178, v178
    v_mfma_f32_32x32x16_bf16 v[160:175], v[232:235], v[136:139], v[160:175]
    v_exp_f32 v179, v179
    v_exp_f32 v180, v180
    v_exp_f32 v181, v181
    v_mfma_f32_32x32x16_bf16 v[192:207], v[156:159], v[28:31], v[192:207]
    v_exp_f32 v182, v182
    v_exp_f32 v183, v183
    v_exp_f32 v184, v184
    v_mfma_f32_32x32x16_bf16 v[160:175], v[236:239], v[140:143], v[160:175]
    v_exp_f32 v185, v185
    v_exp_f32 v186, v186
    v_exp_f32 v187, v187
    v_exp_f32 v188, v188
    v_exp_f32 v189, v189
    v_exp_f32 v190, v190
    v_exp_f32 v191, v191
    v_cvt_pk_bf16_f32 v128, v176, v177
    v_cvt_pk_bf16_f32 v129, v178, v179
    v_cvt_pk_bf16_f32 v130, v180, v181
    v_cvt_pk_bf16_f32 v131, v182, v183
    v_cvt_pk_bf16_f32 v132, v184, v185
    v_cvt_pk_bf16_f32 v133, v186, v187
    v_cvt_pk_bf16_f32 v134, v188, v189
    v_cvt_pk_bf16_f32 v135, v190, v191
    s_mov_b64 exec, s[92:93]
    buffer_load_dwordx4 v[232:235], v2, s[4:7], s69 offen sc1
    buffer_load_dwordx4 v[236:239], v3, s[4:7], s69 offen sc1
    s_mov_b64 exec, -1
    v_mfma_f32_32x32x16_bf16 v[176:191], v[152:155], v[32:35], 0
    v_exp_f32 v192, v192
    v_exp_f32 v193, v193
    v_exp_f32 v194, v194
    v_mfma_f32_32x32x16_bf16 v[80:95], v[240:243], v[128:131], v[80:95]
    v_exp_f32 v195, v195
    v_exp_f32 v196, v196
    v_exp_f32 v197, v197
    v_mfma_f32_32x32x16_bf16 v[176:191], v[156:159], v[36:39], v[176:191]
    v_exp_f32 v198, v198
    v_exp_f32 v199, v199
    v_exp_f32 v200, v200
    v_mfma_f32_32x32x16_bf16 v[80:95], v[244:247], v[132:135], v[80:95]
    v_exp_f32 v201, v201
    v_exp_f32 v202, v202
    v_exp_f32 v203, v203
    v_exp_f32 v204, v204
    v_exp_f32 v205, v205
    v_exp_f32 v206, v206
    v_exp_f32 v207, v207
    v_cvt_pk_bf16_f32 v136, v192, v193
    v_cvt_pk_bf16_f32 v137, v194, v195
    v_cvt_pk_bf16_f32 v138, v196, v197
    v_cvt_pk_bf16_f32 v139, v198, v199
    v_cvt_pk_bf16_f32 v140, v200, v201
    v_cvt_pk_bf16_f32 v141, v202, v203
    v_cvt_pk_bf16_f32 v142, v204, v205
    v_cvt_pk_bf16_f32 v143, v206, v207
    v_mfma_f32_32x32x16_bf16 v[192:207], v[152:155], v[40:43], 0
    v_exp_f32 v176, v176
    v_exp_f32 v177, v177
    v_exp_f32 v178, v178
    v_mfma_f32_32x32x16_bf16 v[96:111], v[240:243], v[136:139], v[96:111]
    v_exp_f32 v179, v179
    v_exp_f32 v180, v180
    v_exp_f32 v181, v181
    v_mfma_f32_32x32x16_bf16 v[192:207], v[156:159], v[44:47], v[192:207]
    v_exp_f32 v182, v182
    v_exp_f32 v183, v183
    v_exp_f32 v184, v184
    v_mfma_f32_32x32x16_bf16 v[96:111], v[244:247], v[140:143], v[96:111]
    v_exp_f32 v185, v185
    v_exp_f32 v186, v186
    v_exp_f32 v187, v187
    v_exp_f32 v188, v188
    v_exp_f32 v189, v189
    v_exp_f32 v190, v190
    v_exp_f32 v191, v191
    v_cvt_pk_bf16_f32 v128, v176, v177
    v_cvt_pk_bf16_f32 v129, v178, v179
    v_cvt_pk_bf16_f32 v130, v180, v181
    v_cvt_pk_bf16_f32 v131, v182, v183
    v_cvt_pk_bf16_f32 v132, v184, v185
    v_cvt_pk_bf16_f32 v133, v186, v187
    v_cvt_pk_bf16_f32 v134, v188, v189
    v_cvt_pk_bf16_f32 v135, v190, v191
    buffer_load_dwordx4 v[152:155], v8, s[4:7], s70 offen offset:0 sc1
    buffer_load_dwordx4 v[156:159], v8, s[4:7], s70 offen offset:1024 sc1
    s_waitcnt vmcnt(10)
    v_mfma_f32_32x32x16_bf16 v[176:191], v[48:51], v[16:19], 0
    v_exp_f32 v192, v192
    v_exp_f32 v193, v193
    v_exp_f32 v194, v194
    v_mfma_f32_32x32x16_bf16 v[112:127], v[240:243], v[128:131], v[112:127]
    v_exp_f32 v195, v195
    v_exp_f32 v196, v196
    v_exp_f32 v197, v197
    v_mfma_f32_32x32x16_bf16 v[176:191], v[52:55], v[20:23], v[176:191]
    v_exp_f32 v198, v198
    v_exp_f32 v199, v199
    v_exp_f32 v200, v200
    v_mfma_f32_32x32x16_bf16 v[112:127], v[244:247], v[132:135], v[112:127]
    v_exp_f32 v201, v201
    v_exp_f32 v202, v202
    v_exp_f32 v203, v203
    v_exp_f32 v204, v204
    v_exp_f32 v205, v205
    v_exp_f32 v206, v206
    v_exp_f32 v207, v207
    v_cvt_pk_bf16_f32 v136, v192, v193
    v_cvt_pk_bf16_f32 v137, v194, v195
    v_cvt_pk_bf16_f32 v138, v196, v197
    v_cvt_pk_bf16_f32 v139, v198, v199
    v_cvt_pk_bf16_f32 v140, v200, v201
    v_cvt_pk_bf16_f32 v141, v202, v203
    v_cvt_pk_bf16_f32 v142, v204, v205
    v_cvt_pk_bf16_f32 v143, v206, v207
    v_mfma_f32_32x32x16_bf16 v[192:207], v[48:51], v[24:27], 0
    v_exp_f32 v176, v176
    v_exp_f32 v177, v177
    v_exp_f32 v178, v178
    v_mfma_f32_32x32x16_bf16 v[160:175], v[240:243], v[136:139], v[160:175]
    v_exp_f32 v179, v179
    v_exp_f32 v180, v180
    v_exp_f32 v181, v181
    v_mfma_f32_32x32x16_bf16 v[192:207], v[52:55], v[28:31], v[192:207]
    v_exp_f32 v182, v182
    v_exp_f32 v183, v183
    v_exp_f32 v184, v184
    v_mfma_f32_32x32x16_bf16 v[160:175], v[244:247], v[140:143], v[160:175]
    v_exp_f32 v185, v185
    v_exp_f32 v186, v186
    v_exp_f32 v187, v187
    v_exp_f32 v188, v188
    v_exp_f32 v189, v189
    v_exp_f32 v190, v190
    v_exp_f32 v191, v191
    v_cvt_pk_bf16_f32 v128, v176, v177
    v_cvt_pk_bf16_f32 v129, v178, v179
    v_cvt_pk_bf16_f32 v130, v180, v181
    v_cvt_pk_bf16_f32 v131, v182, v183
    v_cvt_pk_bf16_f32 v132, v184, v185
    v_cvt_pk_bf16_f32 v133, v186, v187
    v_cvt_pk_bf16_f32 v134, v188, v189
    v_cvt_pk_bf16_f32 v135, v190, v191
    s_mov_b64 exec, s[92:93]
    buffer_load_dwordx4 v[240:243], v2, s[4:7], s70 offen sc1
    buffer_load_dwordx4 v[244:247], v3, s[4:7], s70 offen sc1
    s_mov_b64 exec, -1
    v_mfma_f32_32x32x16_bf16 v[176:191], v[48:51], v[32:35], 0
    v_exp_f32 v192, v192
    v_exp_f32 v193, v193
    v_exp_f32 v194, v194
    v_mfma_f32_32x32x16_bf16 v[80:95], v[64:67], v[128:131], v[80:95]
    v_exp_f32 v195, v195
    v_exp_f32 v196, v196
    v_exp_f32 v197, v197
    v_mfma_f32_32x32x16_bf16 v[176:191], v[52:55], v[36:39], v[176:191]
    v_exp_f32 v198, v198
    v_exp_f32 v199, v199
    v_exp_f32 v200, v200
    v_mfma_f32_32x32x16_bf16 v[80:95], v[68:71], v[132:135], v[80:95]
    v_exp_f32 v201, v201
    v_exp_f32 v202, v202
    v_exp_f32 v203, v203
    v_exp_f32 v204, v204
    v_exp_f32 v205, v205
    v_exp_f32 v206, v206
    v_exp_f32 v207, v207
    v_cvt_pk_bf16_f32 v136, v192, v193
    v_cvt_pk_bf16_f32 v137, v194, v195
    v_cvt_pk_bf16_f32 v138, v196, v197
    v_cvt_pk_bf16_f32 v139, v198, v199
    v_cvt_pk_bf16_f32 v140, v200, v201
    v_cvt_pk_bf16_f32 v141, v202, v203
    v_cvt_pk_bf16_f32 v142, v204, v205
    v_cvt_pk_bf16_f32 v143, v206, v207
    v_mfma_f32_32x32x16_bf16 v[192:207], v[48:51], v[40:43], 0
    v_exp_f32 v176, v176
    v_exp_f32 v177, v177
    v_exp_f32 v178, v178
    v_mfma_f32_32x32x16_bf16 v[96:111], v[64:67], v[136:139], v[96:111]
    v_exp_f32 v179, v179
    v_exp_f32 v180, v180
    v_exp_f32 v181, v181
    v_mfma_f32_32x32x16_bf16 v[192:207], v[52:55], v[44:47], v[192:207]
    v_exp_f32 v182, v182
    v_exp_f32 v183, v183
    v_exp_f32 v184, v184
    v_mfma_f32_32x32x16_bf16 v[96:111], v[68:71], v[140:143], v[96:111]
    v_exp_f32 v185, v185
    v_exp_f32 v186, v186
    v_exp_f32 v187, v187
    v_exp_f32 v188, v188
    v_exp_f32 v189, v189
    v_exp_f32 v190, v190
    v_exp_f32 v191, v191
    v_cvt_pk_bf16_f32 v128, v176, v177
    v_cvt_pk_bf16_f32 v129, v178, v179
    v_cvt_pk_bf16_f32 v130, v180, v181
    v_cvt_pk_bf16_f32 v131, v182, v183
    v_cvt_pk_bf16_f32 v132, v184, v185
    v_cvt_pk_bf16_f32 v133, v186, v187
    v_cvt_pk_bf16_f32 v134, v188, v189
    v_cvt_pk_bf16_f32 v135, v190, v191
    buffer_load_dwordx4 v[48:51], v8, s[4:7], s71 offen offset:0 sc1
    buffer_load_dwordx4 v[52:55], v8, s[4:7], s71 offen offset:1024 sc1
    s_waitcnt vmcnt(10)
    v_mfma_f32_32x32x16_bf16 v[176:191], v[56:59], v[16:19], 0
    v_exp_f32 v192, v192
    v_exp_f32 v193, v193
    v_exp_f32 v194, v194
    v_mfma_f32_32x32x16_bf16 v[112:127], v[64:67], v[128:131], v[112:127]
    v_exp_f32 v195, v195
    v_exp_f32 v196, v196
    v_exp_f32 v197, v197
    v_mfma_f32_32x32x16_bf16 v[176:191], v[60:63], v[20:23], v[176:191]
    v_exp_f32 v198, v198
    v_exp_f32 v199, v199
    v_exp_f32 v200, v200
    v_mfma_f32_32x32x16_bf16 v[112:127], v[68:71], v[132:135], v[112:127]
    v_exp_f32 v201, v201
    v_exp_f32 v202, v202
    v_exp_f32 v203, v203
    v_exp_f32 v204, v204
    v_exp_f32 v205, v205
    v_exp_f32 v206, v206
    v_exp_f32 v207, v207
    v_cvt_pk_bf16_f32 v136, v192, v193
    v_cvt_pk_bf16_f32 v137, v194, v195
    v_cvt_pk_bf16_f32 v138, v196, v197
    v_cvt_pk_bf16_f32 v139, v198, v199
    v_cvt_pk_bf16_f32 v140, v200, v201
    v_cvt_pk_bf16_f32 v141, v202, v203
    v_cvt_pk_bf16_f32 v142, v204, v205
    v_cvt_pk_bf16_f32 v143, v206, v207
    v_mfma_f32_32x32x16_bf16 v[192:207], v[56:59], v[24:27], 0
    v_exp_f32 v176, v176
    v_exp_f32 v177, v177
    v_exp_f32 v178, v178
    v_mfma_f32_32x32x16_bf16 v[160:175], v[64:67], v[136:139], v[160:175]
    v_exp_f32 v179, v179
    v_exp_f32 v180, v180
    v_exp_f32 v181, v181
    v_mfma_f32_32x32x16_bf16 v[192:207], v[60:63], v[28:31], v[192:207]
    v_exp_f32 v182, v182
    v_exp_f32 v183, v183
    v_exp_f32 v184, v184
    v_mfma_f32_32x32x16_bf16 v[160:175], v[68:71], v[140:143], v[160:175]
    v_exp_f32 v185, v185
    v_exp_f32 v186, v186
    v_exp_f32 v187, v187
    v_exp_f32 v188, v188
    v_exp_f32 v189, v189
    v_exp_f32 v190, v190
    v_exp_f32 v191, v191
    v_cvt_pk_bf16_f32 v128, v176, v177
    v_cvt_pk_bf16_f32 v129, v178, v179
    v_cvt_pk_bf16_f32 v130, v180, v181
    v_cvt_pk_bf16_f32 v131, v182, v183
    v_cvt_pk_bf16_f32 v132, v184, v185
    v_cvt_pk_bf16_f32 v133, v186, v187
    v_cvt_pk_bf16_f32 v134, v188, v189
    v_cvt_pk_bf16_f32 v135, v190, v191
    s_mov_b64 exec, s[92:93]
    buffer_load_dwordx4 v[64:67], v2, s[4:7], s71 offen sc1
    buffer_load_dwordx4 v[68:71], v3, s[4:7], s71 offen sc1
    s_mov_b64 exec, -1
    v_mfma_f32_32x32x16_bf16 v[176:191], v[56:59], v[32:35], 0
    v_exp_f32 v192, v192
    v_exp_f32 v193, v193
    v_exp_f32 v194, v194
    v_mfma_f32_32x32x16_bf16 v[80:95], v[72:75], v[128:131], v[80:95]
    v_exp_f32 v195, v195
    v_exp_f32 v196, v196
    v_exp_f32 v197, v197
    v_mfma_f32_32x32x16_bf16 v[176:191], v[60:63], v[36:39], v[176:191]
    v_exp_f32 v198, v198
    v_exp_f32 v199, v199
    v_exp_f32 v200, v200
    v_mfma_f32_32x32x16_bf16 v[80:95], v[76:79], v[132:135], v[80:95]
    v_exp_f32 v201, v201
    v_exp_f32 v202, v202
    v_exp_f32 v203, v203
    v_exp_f32 v204, v204
    v_exp_f32 v205, v205
    v_exp_f32 v206, v206
    v_exp_f32 v207, v207
    v_cvt_pk_bf16_f32 v136, v192, v193
    v_cvt_pk_bf16_f32 v137, v194, v195
    v_cvt_pk_bf16_f32 v138, v196, v197
    v_cvt_pk_bf16_f32 v139, v198, v199
    v_cvt_pk_bf16_f32 v140, v200, v201
    v_cvt_pk_bf16_f32 v141, v202, v203
    v_cvt_pk_bf16_f32 v142, v204, v205
    v_cvt_pk_bf16_f32 v143, v206, v207
    v_mfma_f32_32x32x16_bf16 v[192:207], v[56:59], v[40:43], 0
    v_exp_f32 v176, v176
    v_exp_f32 v177, v177
    v_exp_f32 v178, v178
    v_mfma_f32_32x32x16_bf16 v[96:111], v[72:75], v[136:139], v[96:111]
    v_exp_f32 v179, v179
    v_exp_f32 v180, v180
    v_exp_f32 v181, v181
    v_mfma_f32_32x32x16_bf16 v[192:207], v[60:63], v[44:47], v[192:207]
    v_exp_f32 v182, v182
    v_exp_f32 v183, v183
    v_exp_f32 v184, v184
    v_mfma_f32_32x32x16_bf16 v[96:111], v[76:79], v[140:143], v[96:111]
    v_exp_f32 v185, v185
    v_exp_f32 v186, v186
    v_exp_f32 v187, v187
    v_exp_f32 v188, v188
    v_exp_f32 v189, v189
    v_exp_f32 v190, v190
    v_exp_f32 v191, v191
    v_cvt_pk_bf16_f32 v128, v176, v177
    v_cvt_pk_bf16_f32 v129, v178, v179
    v_cvt_pk_bf16_f32 v130, v180, v181
    v_cvt_pk_bf16_f32 v131, v182, v183
    v_cvt_pk_bf16_f32 v132, v184, v185
    v_cvt_pk_bf16_f32 v133, v186, v187
    v_cvt_pk_bf16_f32 v134, v188, v189
    v_cvt_pk_bf16_f32 v135, v190, v191
    buffer_load_dwordx4 v[56:59], v8, s[4:7], s72 offen offset:0 sc1
    buffer_load_dwordx4 v[60:63], v8, s[4:7], s72 offen offset:1024 sc1
    s_waitcnt vmcnt(10)
    v_mfma_f32_32x32x16_bf16 v[176:191], v[144:147], v[16:19], 0
    v_exp_f32 v192, v192
    v_exp_f32 v193, v193
    v_exp_f32 v194, v194
    v_mfma_f32_32x32x16_bf16 v[112:127], v[72:75], v[128:131], v[112:127]
    v_exp_f32 v195, v195
    v_exp_f32 v196, v196
    v_exp_f32 v197, v197
    v_mfma_f32_32x32x16_bf16 v[176:191], v[148:151], v[20:23], v[176:191]
    v_exp_f32 v198, v198
    v_exp_f32 v199, v199
    v_exp_f32 v200, v200
    v_mfma_f32_32x32x16_bf16 v[112:127], v[76:79], v[132:135], v[112:127]
    v_exp_f32 v201, v201
    v_exp_f32 v202, v202
    v_exp_f32 v203, v203
    v_exp_f32 v204, v204
    v_exp_f32 v205, v205
    v_exp_f32 v206, v206
    v_exp_f32 v207, v207
    v_cvt_pk_bf16_f32 v136, v192, v193
    v_cvt_pk_bf16_f32 v137, v194, v195
    v_cvt_pk_bf16_f32 v138, v196, v197
    v_cvt_pk_bf16_f32 v139, v198, v199
    v_cvt_pk_bf16_f32 v140, v200, v201
    v_cvt_pk_bf16_f32 v141, v202, v203
    v_cvt_pk_bf16_f32 v142, v204, v205
    v_cvt_pk_bf16_f32 v143, v206, v207
    v_mfma_f32_32x32x16_bf16 v[192:207], v[144:147], v[24:27], 0
    v_exp_f32 v176, v176
    v_exp_f32 v177, v177
    v_exp_f32 v178, v178
    v_mfma_f32_32x32x16_bf16 v[160:175], v[72:75], v[136:139], v[160:175]
    v_exp_f32 v179, v179
    v_exp_f32 v180, v180
    v_exp_f32 v181, v181
    v_mfma_f32_32x32x16_bf16 v[192:207], v[148:151], v[28:31], v[192:207]
    v_exp_f32 v182, v182
    v_exp_f32 v183, v183
    v_exp_f32 v184, v184
    v_mfma_f32_32x32x16_bf16 v[160:175], v[76:79], v[140:143], v[160:175]
    v_exp_f32 v185, v185
    v_exp_f32 v186, v186
    v_exp_f32 v187, v187
    v_exp_f32 v188, v188
    v_exp_f32 v189, v189
    v_exp_f32 v190, v190
    v_exp_f32 v191, v191
    v_cvt_pk_bf16_f32 v128, v176, v177
    v_cvt_pk_bf16_f32 v129, v178, v179
    v_cvt_pk_bf16_f32 v130, v180, v181
    v_cvt_pk_bf16_f32 v131, v182, v183
    v_cvt_pk_bf16_f32 v132, v184, v185
    v_cvt_pk_bf16_f32 v133, v186, v187
    v_cvt_pk_bf16_f32 v134, v188, v189
    v_cvt_pk_bf16_f32 v135, v190, v191
    s_mov_b64 exec, s[92:93]
    buffer_load_dwordx4 v[72:75], v2, s[4:7], s72 offen sc1
    buffer_load_dwordx4 v[76:79], v3, s[4:7], s72 offen sc1
    s_mov_b64 exec, -1
    v_mfma_f32_32x32x16_bf16 v[176:191], v[144:147], v[32:35], 0
    v_exp_f32 v192, v192
    v_exp_f32 v193, v193
    v_exp_f32 v194, v194
    v_mfma_f32_32x32x16_bf16 v[80:95], v[232:235], v[128:131], v[80:95]
    v_exp_f32 v195, v195
    v_exp_f32 v196, v196
    v_exp_f32 v197, v197
    v_mfma_f32_32x32x16_bf16 v[176:191], v[148:151], v[36:39], v[176:191]
    v_exp_f32 v198, v198
    v_exp_f32 v199, v199
    v_exp_f32 v200, v200
    v_mfma_f32_32x32x16_bf16 v[80:95], v[236:239], v[132:135], v[80:95]
    v_exp_f32 v201, v201
    v_exp_f32 v202, v202
    v_exp_f32 v203, v203
    v_exp_f32 v204, v204
    v_exp_f32 v205, v205
    v_exp_f32 v206, v206
    v_exp_f32 v207, v207
    v_cvt_pk_bf16_f32 v136, v192, v193
    v_cvt_pk_bf16_f32 v137, v194, v195
    v_cvt_pk_bf16_f32 v138, v196, v197
    v_cvt_pk_bf16_f32 v139, v198, v199
    v_cvt_pk_bf16_f32 v140, v200, v201
    v_cvt_pk_bf16_f32 v141, v202, v203
    v_cvt_pk_bf16_f32 v142, v204, v205
    v_cvt_pk_bf16_f32 v143, v206, v207
    v_mfma_f32_32x32x16_bf16 v[192:207], v[144:147], v[40:43], 0
    v_exp_f32 v176, v176
    v_exp_f32 v177, v177
    v_exp_f32 v178, v178
    v_mfma_f32_32x32x16_bf16 v[96:111], v[232:235], v[136:139], v[96:111]
    v_exp_f32 v179, v179
    v_exp_f32 v180, v180
    v_exp_f32 v181, v181
    v_mfma_f32_32x32x16_bf16 v[192:207], v[148:151], v[44:47], v[192:207]
    v_exp_f32 v182, v182
    v_exp_f32 v183, v183
    v_exp_f32 v184, v184
    v_mfma_f32_32x32x16_bf16 v[96:111], v[236:239], v[140:143], v[96:111]
    v_exp_f32 v185, v185
    v_exp_f32 v186, v186
    v_exp_f32 v187, v187
    v_exp_f32 v188, v188
    v_exp_f32 v189, v189
    v_exp_f32 v190, v190
    v_exp_f32 v191, v191
    v_cvt_pk_bf16_f32 v128, v176, v177
    v_cvt_pk_bf16_f32 v129, v178, v179
    v_cvt_pk_bf16_f32 v130, v180, v181
    v_cvt_pk_bf16_f32 v131, v182, v183
    v_cvt_pk_bf16_f32 v132, v184, v185
    v_cvt_pk_bf16_f32 v133, v186, v187
    v_cvt_pk_bf16_f32 v134, v188, v189
    v_cvt_pk_bf16_f32 v135, v190, v191
    buffer_load_dwordx4 v[144:147], v8, s[4:7], s73 offen offset:0 sc1
    buffer_load_dwordx4 v[148:151], v8, s[4:7], s73 offen offset:1024 sc1
    s_waitcnt vmcnt(10)
    v_mfma_f32_32x32x16_bf16 v[176:191], v[152:155], v[16:19], 0
    v_exp_f32 v192, v192
    v_exp_f32 v193, v193
    v_exp_f32 v194, v194
    v_mfma_f32_32x32x16_bf16 v[112:127], v[232:235], v[128:131], v[112:127]
    v_exp_f32 v195, v195
    v_exp_f32 v196, v196
    v_exp_f32 v197, v197
    v_mfma_f32_32x32x16_bf16 v[176:191], v[156:159], v[20:23], v[176:191]
    v_exp_f32 v198, v198
    v_exp_f32 v199, v199
    v_exp_f32 v200, v200
    v_mfma_f32_32x32x16_bf16 v[112:127], v[236:239], v[132:135], v[112:127]
    v_exp_f32 v201, v201
    v_exp_f32 v202, v202
    v_exp_f32 v203, v203
    v_exp_f32 v204, v204
    v_exp_f32 v205, v205
    v_exp_f32 v206, v206
    v_exp_f32 v207, v207
    v_cvt_pk_bf16_f32 v136, v192, v193
    v_cvt_pk_bf16_f32 v137, v194, v195
    v_cvt_pk_bf16_f32 v138, v196, v197
    v_cvt_pk_bf16_f32 v139, v198, v199
    v_cvt_pk_bf16_f32 v140, v200, v201
    v_cvt_pk_bf16_f32 v141, v202, v203
    v_cvt_pk_bf16_f32 v142, v204, v205
    v_cvt_pk_bf16_f32 v143, v206, v207
    v_mfma_f32_32x32x16_bf16 v[192:207], v[152:155], v[24:27], 0
    v_exp_f32 v176, v176
    v_exp_f32 v177, v177
    v_exp_f32 v178, v178
    v_mfma_f32_32x32x16_bf16 v[160:175], v[232:235], v[136:139], v[160:175]
    v_exp_f32 v179, v179
    v_exp_f32 v180, v180
    v_exp_f32 v181, v181
    v_mfma_f32_32x32x16_bf16 v[192:207], v[156:159], v[28:31], v[192:207]
    v_exp_f32 v182, v182
    v_exp_f32 v183, v183
    v_exp_f32 v184, v184
    v_mfma_f32_32x32x16_bf16 v[160:175], v[236:239], v[140:143], v[160:175]
    v_exp_f32 v185, v185
    v_exp_f32 v186, v186
    v_exp_f32 v187, v187
    v_exp_f32 v188, v188
    v_exp_f32 v189, v189
    v_exp_f32 v190, v190
    v_exp_f32 v191, v191
    v_cvt_pk_bf16_f32 v128, v176, v177
    v_cvt_pk_bf16_f32 v129, v178, v179
    v_cvt_pk_bf16_f32 v130, v180, v181
    v_cvt_pk_bf16_f32 v131, v182, v183
    v_cvt_pk_bf16_f32 v132, v184, v185
    v_cvt_pk_bf16_f32 v133, v186, v187
    v_cvt_pk_bf16_f32 v134, v188, v189
    v_cvt_pk_bf16_f32 v135, v190, v191
    s_mov_b64 exec, s[92:93]
    buffer_load_dwordx4 v[232:235], v2, s[4:7], s73 offen sc1
    buffer_load_dwordx4 v[236:239], v3, s[4:7], s73 offen sc1
    s_mov_b64 exec, -1
    v_mfma_f32_32x32x16_bf16 v[176:191], v[152:155], v[32:35], 0
    v_exp_f32 v192, v192
    v_exp_f32 v193, v193
    v_exp_f32 v194, v194
    v_mfma_f32_32x32x16_bf16 v[80:95], v[240:243], v[128:131], v[80:95]
    v_exp_f32 v195, v195
    v_exp_f32 v196, v196
    v_exp_f32 v197, v197
    v_mfma_f32_32x32x16_bf16 v[176:191], v[156:159], v[36:39], v[176:191]
    v_exp_f32 v198, v198
    v_exp_f32 v199, v199
    v_exp_f32 v200, v200
    v_mfma_f32_32x32x16_bf16 v[80:95], v[244:247], v[132:135], v[80:95]
    v_exp_f32 v201, v201
    v_exp_f32 v202, v202
    v_exp_f32 v203, v203
    v_exp_f32 v204, v204
    v_exp_f32 v205, v205
    v_exp_f32 v206, v206
    v_exp_f32 v207, v207
    v_cvt_pk_bf16_f32 v136, v192, v193
    v_cvt_pk_bf16_f32 v137, v194, v195
    v_cvt_pk_bf16_f32 v138, v196, v197
    v_cvt_pk_bf16_f32 v139, v198, v199
    v_cvt_pk_bf16_f32 v140, v200, v201
    v_cvt_pk_bf16_f32 v141, v202, v203
    v_cvt_pk_bf16_f32 v142, v204, v205
    v_cvt_pk_bf16_f32 v143, v206, v207
    v_mfma_f32_32x32x16_bf16 v[192:207], v[152:155], v[40:43], 0
    v_exp_f32 v176, v176
    v_exp_f32 v177, v177
    v_exp_f32 v178, v178
    v_mfma_f32_32x32x16_bf16 v[96:111], v[240:243], v[136:139], v[96:111]
    v_exp_f32 v179, v179
    v_exp_f32 v180, v180
    v_exp_f32 v181, v181
    v_mfma_f32_32x32x16_bf16 v[192:207], v[156:159], v[44:47], v[192:207]
    v_exp_f32 v182, v182
    v_exp_f32 v183, v183
    v_exp_f32 v184, v184
    v_mfma_f32_32x32x16_bf16 v[96:111], v[244:247], v[140:143], v[96:111]
    v_exp_f32 v185, v185
    v_exp_f32 v186, v186
    v_exp_f32 v187, v187
    v_exp_f32 v188, v188
    v_exp_f32 v189, v189
    v_exp_f32 v190, v190
    v_exp_f32 v191, v191
    v_cvt_pk_bf16_f32 v128, v176, v177
    v_cvt_pk_bf16_f32 v129, v178, v179
    v_cvt_pk_bf16_f32 v130, v180, v181
    v_cvt_pk_bf16_f32 v131, v182, v183
    v_cvt_pk_bf16_f32 v132, v184, v185
    v_cvt_pk_bf16_f32 v133, v186, v187
    v_cvt_pk_bf16_f32 v134, v188, v189
    v_cvt_pk_bf16_f32 v135, v190, v191
    buffer_load_dwordx4 v[152:155], v8, s[4:7], s74 offen offset:0 sc1
    buffer_load_dwordx4 v[156:159], v8, s[4:7], s74 offen offset:1024 sc1
    s_waitcnt vmcnt(10)
    v_mfma_f32_32x32x16_bf16 v[176:191], v[48:51], v[16:19], 0
    v_exp_f32 v192, v192
    v_exp_f32 v193, v193
    v_exp_f32 v194, v194
    v_mfma_f32_32x32x16_bf16 v[112:127], v[240:243], v[128:131], v[112:127]
    v_exp_f32 v195, v195
    v_exp_f32 v196, v196
    v_exp_f32 v197, v197
    v_mfma_f32_32x32x16_bf16 v[176:191], v[52:55], v[20:23], v[176:191]
    v_exp_f32 v198, v198
    v_exp_f32 v199, v199
    v_exp_f32 v200, v200
    v_mfma_f32_32x32x16_bf16 v[112:127], v[244:247], v[132:135], v[112:127]
    v_exp_f32 v201, v201
    v_exp_f32 v202, v202
    v_exp_f32 v203, v203
    v_exp_f32 v204, v204
    v_exp_f32 v205, v205
    v_exp_f32 v206, v206
    v_exp_f32 v207, v207
    v_cvt_pk_bf16_f32 v136, v192, v193
    v_cvt_pk_bf16_f32 v137, v194, v195
    v_cvt_pk_bf16_f32 v138, v196, v197
    v_cvt_pk_bf16_f32 v139, v198, v199
    v_cvt_pk_bf16_f32 v140, v200, v201
    v_cvt_pk_bf16_f32 v141, v202, v203
    v_cvt_pk_bf16_f32 v142, v204, v205
    v_cvt_pk_bf16_f32 v143, v206, v207
    v_mfma_f32_32x32x16_bf16 v[192:207], v[48:51], v[24:27], 0
    v_exp_f32 v176, v176
    v_exp_f32 v177, v177
    v_exp_f32 v178, v178
    v_mfma_f32_32x32x16_bf16 v[160:175], v[240:243], v[136:139], v[160:175]
    v_exp_f32 v179, v179
    v_exp_f32 v180, v180
    v_exp_f32 v181, v181
    v_mfma_f32_32x32x16_bf16 v[192:207], v[52:55], v[28:31], v[192:207]
    v_exp_f32 v182, v182
    v_exp_f32 v183, v183
    v_exp_f32 v184, v184
    v_mfma_f32_32x32x16_bf16 v[160:175], v[244:247], v[140:143], v[160:175]
    v_exp_f32 v185, v185
    v_exp_f32 v186, v186
    v_exp_f32 v187, v187
    v_exp_f32 v188, v188
    v_exp_f32 v189, v189
    v_exp_f32 v190, v190
    v_exp_f32 v191, v191
    v_cvt_pk_bf16_f32 v128, v176, v177
    v_cvt_pk_bf16_f32 v129, v178, v179
    v_cvt_pk_bf16_f32 v130, v180, v181
    v_cvt_pk_bf16_f32 v131, v182, v183
    v_cvt_pk_bf16_f32 v132, v184, v185
    v_cvt_pk_bf16_f32 v133, v186, v187
    v_cvt_pk_bf16_f32 v134, v188, v189
    v_cvt_pk_bf16_f32 v135, v190, v191
    s_mov_b64 exec, s[92:93]
    buffer_load_dwordx4 v[240:243], v2, s[4:7], s74 offen sc1
    buffer_load_dwordx4 v[244:247], v3, s[4:7], s74 offen sc1
    s_mov_b64 exec, -1
    v_mfma_f32_32x32x16_bf16 v[176:191], v[48:51], v[32:35], 0
    v_exp_f32 v192, v192
    v_exp_f32 v193, v193
    v_exp_f32 v194, v194
    v_mfma_f32_32x32x16_bf16 v[80:95], v[64:67], v[128:131], v[80:95]
    v_exp_f32 v195, v195
    v_exp_f32 v196, v196
    v_exp_f32 v197, v197
    v_mfma_f32_32x32x16_bf16 v[176:191], v[52:55], v[36:39], v[176:191]
    v_exp_f32 v198, v198
    v_exp_f32 v199, v199
    v_exp_f32 v200, v200
    v_mfma_f32_32x32x16_bf16 v[80:95], v[68:71], v[132:135], v[80:95]
    v_exp_f32 v201, v201
    v_exp_f32 v202, v202
    v_exp_f32 v203, v203
    v_exp_f32 v204, v204
    v_exp_f32 v205, v205
    v_exp_f32 v206, v206
    v_exp_f32 v207, v207
    v_cvt_pk_bf16_f32 v136, v192, v193
    v_cvt_pk_bf16_f32 v137, v194, v195
    v_cvt_pk_bf16_f32 v138, v196, v197
    v_cvt_pk_bf16_f32 v139, v198, v199
    v_cvt_pk_bf16_f32 v140, v200, v201
    v_cvt_pk_bf16_f32 v141, v202, v203
    v_cvt_pk_bf16_f32 v142, v204, v205
    v_cvt_pk_bf16_f32 v143, v206, v207
    v_mfma_f32_32x32x16_bf16 v[192:207], v[48:51], v[40:43], 0
    v_exp_f32 v176, v176
    v_exp_f32 v177, v177
    v_exp_f32 v178, v178
    v_mfma_f32_32x32x16_bf16 v[96:111], v[64:67], v[136:139], v[96:111]
    v_exp_f32 v179, v179
    v_exp_f32 v180, v180
    v_exp_f32 v181, v181
    v_mfma_f32_32x32x16_bf16 v[192:207], v[52:55], v[44:47], v[192:207]
    v_exp_f32 v182, v182
    v_exp_f32 v183, v183
    v_exp_f32 v184, v184
    v_mfma_f32_32x32x16_bf16 v[96:111], v[68:71], v[140:143], v[96:111]
    v_exp_f32 v185, v185
    v_exp_f32 v186, v186
    v_exp_f32 v187, v187
    v_exp_f32 v188, v188
    v_exp_f32 v189, v189
    v_exp_f32 v190, v190
    v_exp_f32 v191, v191
    v_cvt_pk_bf16_f32 v128, v176, v177
    v_cvt_pk_bf16_f32 v129, v178, v179
    v_cvt_pk_bf16_f32 v130, v180, v181
    v_cvt_pk_bf16_f32 v131, v182, v183
    v_cvt_pk_bf16_f32 v132, v184, v185
    v_cvt_pk_bf16_f32 v133, v186, v187
    v_cvt_pk_bf16_f32 v134, v188, v189
    v_cvt_pk_bf16_f32 v135, v190, v191
    buffer_load_dwordx4 v[48:51], v8, s[4:7], s75 offen offset:0 sc1
    buffer_load_dwordx4 v[52:55], v8, s[4:7], s75 offen offset:1024 sc1
    s_waitcnt vmcnt(10)
    v_mfma_f32_32x32x16_bf16 v[176:191], v[56:59], v[16:19], 0
    v_exp_f32 v192, v192
    v_exp_f32 v193, v193
    v_exp_f32 v194, v194
    v_mfma_f32_32x32x16_bf16 v[112:127], v[64:67], v[128:131], v[112:127]
    v_exp_f32 v195, v195
    v_exp_f32 v196, v196
    v_exp_f32 v197, v197
    v_mfma_f32_32x32x16_bf16 v[176:191], v[60:63], v[20:23], v[176:191]
    v_exp_f32 v198, v198
    v_exp_f32 v199, v199
    v_exp_f32 v200, v200
    v_mfma_f32_32x32x16_bf16 v[112:127], v[68:71], v[132:135], v[112:127]
    v_exp_f32 v201, v201
    v_exp_f32 v202, v202
    v_exp_f32 v203, v203
    v_exp_f32 v204, v204
    v_exp_f32 v205, v205
    v_exp_f32 v206, v206
    v_exp_f32 v207, v207
    v_cvt_pk_bf16_f32 v136, v192, v193
    v_cvt_pk_bf16_f32 v137, v194, v195
    v_cvt_pk_bf16_f32 v138, v196, v197
    v_cvt_pk_bf16_f32 v139, v198, v199
    v_cvt_pk_bf16_f32 v140, v200, v201
    v_cvt_pk_bf16_f32 v141, v202, v203
    v_cvt_pk_bf16_f32 v142, v204, v205
    v_cvt_pk_bf16_f32 v143, v206, v207
    v_mfma_f32_32x32x16_bf16 v[192:207], v[56:59], v[24:27], 0
    v_exp_f32 v176, v176
    v_exp_f32 v177, v177
    v_exp_f32 v178, v178
    v_mfma_f32_32x32x16_bf16 v[160:175], v[64:67], v[136:139], v[160:175]
    v_exp_f32 v179, v179
    v_exp_f32 v180, v180
    v_exp_f32 v181, v181
    v_mfma_f32_32x32x16_bf16 v[192:207], v[60:63], v[28:31], v[192:207]
    v_exp_f32 v182, v182
    v_exp_f32 v183, v183
    v_exp_f32 v184, v184
    v_mfma_f32_32x32x16_bf16 v[160:175], v[68:71], v[140:143], v[160:175]
    v_exp_f32 v185, v185
    v_exp_f32 v186, v186
    v_exp_f32 v187, v187
    v_exp_f32 v188, v188
    v_exp_f32 v189, v189
    v_exp_f32 v190, v190
    v_exp_f32 v191, v191
    v_cvt_pk_bf16_f32 v128, v176, v177
    v_cvt_pk_bf16_f32 v129, v178, v179
    v_cvt_pk_bf16_f32 v130, v180, v181
    v_cvt_pk_bf16_f32 v131, v182, v183
    v_cvt_pk_bf16_f32 v132, v184, v185
    v_cvt_pk_bf16_f32 v133, v186, v187
    v_cvt_pk_bf16_f32 v134, v188, v189
    v_cvt_pk_bf16_f32 v135, v190, v191
    s_mov_b64 exec, s[92:93]
    buffer_load_dwordx4 v[64:67], v2, s[4:7], s75 offen sc1
    buffer_load_dwordx4 v[68:71], v3, s[4:7], s75 offen sc1
    s_mov_b64 exec, -1
    v_mfma_f32_32x32x16_bf16 v[176:191], v[56:59], v[32:35], 0
    v_exp_f32 v192, v192
    v_exp_f32 v193, v193
    v_exp_f32 v194, v194
    v_mfma_f32_32x32x16_bf16 v[80:95], v[72:75], v[128:131], v[80:95]
    v_exp_f32 v195, v195
    v_exp_f32 v196, v196
    v_exp_f32 v197, v197
    v_mfma_f32_32x32x16_bf16 v[176:191], v[60:63], v[36:39], v[176:191]
    v_exp_f32 v198, v198
    v_exp_f32 v199, v199
    v_exp_f32 v200, v200
    v_mfma_f32_32x32x16_bf16 v[80:95], v[76:79], v[132:135], v[80:95]
    v_exp_f32 v201, v201
    v_exp_f32 v202, v202
    v_exp_f32 v203, v203
    v_exp_f32 v204, v204
    v_exp_f32 v205, v205
    v_exp_f32 v206, v206
    v_exp_f32 v207, v207
    v_cvt_pk_bf16_f32 v136, v192, v193
    v_cvt_pk_bf16_f32 v137, v194, v195
    v_cvt_pk_bf16_f32 v138, v196, v197
    v_cvt_pk_bf16_f32 v139, v198, v199
    v_cvt_pk_bf16_f32 v140, v200, v201
    v_cvt_pk_bf16_f32 v141, v202, v203
    v_cvt_pk_bf16_f32 v142, v204, v205
    v_cvt_pk_bf16_f32 v143, v206, v207
    v_mfma_f32_32x32x16_bf16 v[192:207], v[56:59], v[40:43], 0
    v_exp_f32 v176, v176
    v_exp_f32 v177, v177
    v_exp_f32 v178, v178
    v_mfma_f32_32x32x16_bf16 v[96:111], v[72:75], v[136:139], v[96:111]
    v_exp_f32 v179, v179
    v_exp_f32 v180, v180
    v_exp_f32 v181, v181
    v_mfma_f32_32x32x16_bf16 v[192:207], v[60:63], v[44:47], v[192:207]
    v_exp_f32 v182, v182
    v_exp_f32 v183, v183
    v_exp_f32 v184, v184
    v_mfma_f32_32x32x16_bf16 v[96:111], v[76:79], v[140:143], v[96:111]
    v_exp_f32 v185, v185
    v_exp_f32 v186, v186
    v_exp_f32 v187, v187
    v_exp_f32 v188, v188
    v_exp_f32 v189, v189
    v_exp_f32 v190, v190
    v_exp_f32 v191, v191
    v_cvt_pk_bf16_f32 v128, v176, v177
    v_cvt_pk_bf16_f32 v129, v178, v179
    v_cvt_pk_bf16_f32 v130, v180, v181
    v_cvt_pk_bf16_f32 v131, v182, v183
    v_cvt_pk_bf16_f32 v132, v184, v185
    v_cvt_pk_bf16_f32 v133, v186, v187
    v_cvt_pk_bf16_f32 v134, v188, v189
    v_cvt_pk_bf16_f32 v135, v190, v191
    buffer_load_dwordx4 v[56:59], v8, s[4:7], s88 offen offset:0 sc1
    buffer_load_dwordx4 v[60:63], v8, s[4:7], s88 offen offset:1024 sc1
    s_waitcnt vmcnt(10)
    v_mfma_f32_32x32x16_bf16 v[176:191], v[144:147], v[16:19], 0
    v_exp_f32 v192, v192
    v_exp_f32 v193, v193
    v_exp_f32 v194, v194
    v_mfma_f32_32x32x16_bf16 v[112:127], v[72:75], v[128:131], v[112:127]
    v_exp_f32 v195, v195
    v_exp_f32 v196, v196
    v_exp_f32 v197, v197
    v_mfma_f32_32x32x16_bf16 v[176:191], v[148:151], v[20:23], v[176:191]
    v_exp_f32 v198, v198
    v_exp_f32 v199, v199
    v_exp_f32 v200, v200
    v_mfma_f32_32x32x16_bf16 v[112:127], v[76:79], v[132:135], v[112:127]
    v_exp_f32 v201, v201
    v_exp_f32 v202, v202
    v_exp_f32 v203, v203
    v_exp_f32 v204, v204
    v_exp_f32 v205, v205
    v_exp_f32 v206, v206
    v_exp_f32 v207, v207
    v_cvt_pk_bf16_f32 v136, v192, v193
    v_cvt_pk_bf16_f32 v137, v194, v195
    v_cvt_pk_bf16_f32 v138, v196, v197
    v_cvt_pk_bf16_f32 v139, v198, v199
    v_cvt_pk_bf16_f32 v140, v200, v201
    v_cvt_pk_bf16_f32 v141, v202, v203
    v_cvt_pk_bf16_f32 v142, v204, v205
    v_cvt_pk_bf16_f32 v143, v206, v207
    v_mfma_f32_32x32x16_bf16 v[192:207], v[144:147], v[24:27], 0
    v_exp_f32 v176, v176
    v_exp_f32 v177, v177
    v_exp_f32 v178, v178
    v_mfma_f32_32x32x16_bf16 v[160:175], v[72:75], v[136:139], v[160:175]
    v_exp_f32 v179, v179
    v_exp_f32 v180, v180
    v_exp_f32 v181, v181
    v_mfma_f32_32x32x16_bf16 v[192:207], v[148:151], v[28:31], v[192:207]
    v_exp_f32 v182, v182
    v_exp_f32 v183, v183
    v_exp_f32 v184, v184
    v_mfma_f32_32x32x16_bf16 v[160:175], v[76:79], v[140:143], v[160:175]
    v_exp_f32 v185, v185
    v_exp_f32 v186, v186
    v_exp_f32 v187, v187
    v_exp_f32 v188, v188
    v_exp_f32 v189, v189
    v_exp_f32 v190, v190
    v_exp_f32 v191, v191
    v_cvt_pk_bf16_f32 v128, v176, v177
    v_cvt_pk_bf16_f32 v129, v178, v179
    v_cvt_pk_bf16_f32 v130, v180, v181
    v_cvt_pk_bf16_f32 v131, v182, v183
    v_cvt_pk_bf16_f32 v132, v184, v185
    v_cvt_pk_bf16_f32 v133, v186, v187
    v_cvt_pk_bf16_f32 v134, v188, v189
    v_cvt_pk_bf16_f32 v135, v190, v191
    s_mov_b64 exec, s[92:93]
    buffer_load_dwordx4 v[72:75], v2, s[4:7], s88 offen sc1
    buffer_load_dwordx4 v[76:79], v3, s[4:7], s88 offen sc1
    s_mov_b64 exec, -1
    v_mfma_f32_32x32x16_bf16 v[176:191], v[144:147], v[32:35], 0
    v_exp_f32 v192, v192
    v_exp_f32 v193, v193
    v_exp_f32 v194, v194
    v_mfma_f32_32x32x16_bf16 v[80:95], v[232:235], v[128:131], v[80:95]
    v_exp_f32 v195, v195
    v_exp_f32 v196, v196
    v_exp_f32 v197, v197
    v_mfma_f32_32x32x16_bf16 v[176:191], v[148:151], v[36:39], v[176:191]
    v_exp_f32 v198, v198
    v_exp_f32 v199, v199
    v_exp_f32 v200, v200
    v_mfma_f32_32x32x16_bf16 v[80:95], v[236:239], v[132:135], v[80:95]
    v_exp_f32 v201, v201
    v_exp_f32 v202, v202
    v_exp_f32 v203, v203
    v_exp_f32 v204, v204
    v_exp_f32 v205, v205
    v_exp_f32 v206, v206
    v_exp_f32 v207, v207
    v_cvt_pk_bf16_f32 v136, v192, v193
    v_cvt_pk_bf16_f32 v137, v194, v195
    v_cvt_pk_bf16_f32 v138, v196, v197
    v_cvt_pk_bf16_f32 v139, v198, v199
    v_cvt_pk_bf16_f32 v140, v200, v201
    v_cvt_pk_bf16_f32 v141, v202, v203
    v_cvt_pk_bf16_f32 v142, v204, v205
    v_cvt_pk_bf16_f32 v143, v206, v207
    v_mfma_f32_32x32x16_bf16 v[192:207], v[144:147], v[40:43], 0
    v_exp_f32 v176, v176
    v_exp_f32 v177, v177
    v_exp_f32 v178, v178
    v_mfma_f32_32x32x16_bf16 v[96:111], v[232:235], v[136:139], v[96:111]
    v_exp_f32 v179, v179
    v_exp_f32 v180, v180
    v_exp_f32 v181, v181
    v_mfma_f32_32x32x16_bf16 v[192:207], v[148:151], v[44:47], v[192:207]
    v_exp_f32 v182, v182
    v_exp_f32 v183, v183
    v_exp_f32 v184, v184
    v_mfma_f32_32x32x16_bf16 v[96:111], v[236:239], v[140:143], v[96:111]
    v_exp_f32 v185, v185
    v_exp_f32 v186, v186
    v_exp_f32 v187, v187
    v_exp_f32 v188, v188
    v_exp_f32 v189, v189
    v_exp_f32 v190, v190
    v_exp_f32 v191, v191
    v_cvt_pk_bf16_f32 v128, v176, v177
    v_cvt_pk_bf16_f32 v129, v178, v179
    v_cvt_pk_bf16_f32 v130, v180, v181
    v_cvt_pk_bf16_f32 v131, v182, v183
    v_cvt_pk_bf16_f32 v132, v184, v185
    v_cvt_pk_bf16_f32 v133, v186, v187
    v_cvt_pk_bf16_f32 v134, v188, v189
    v_cvt_pk_bf16_f32 v135, v190, v191
    buffer_load_dwordx4 v[144:147], v8, s[4:7], s89 offen offset:0 sc1
    buffer_load_dwordx4 v[148:151], v8, s[4:7], s89 offen offset:1024 sc1
    s_waitcnt vmcnt(10)
    v_mfma_f32_32x32x16_bf16 v[176:191], v[152:155], v[16:19], 0
    v_exp_f32 v192, v192
    v_exp_f32 v193, v193
    v_exp_f32 v194, v194
    v_mfma_f32_32x32x16_bf16 v[112:127], v[232:235], v[128:131], v[112:127]
    v_exp_f32 v195, v195
    v_exp_f32 v196, v196
    v_exp_f32 v197, v197
    v_mfma_f32_32x32x16_bf16 v[176:191], v[156:159], v[20:23], v[176:191]
    v_exp_f32 v198, v198
    v_exp_f32 v199, v199
    v_exp_f32 v200, v200
    v_mfma_f32_32x32x16_bf16 v[112:127], v[236:239], v[132:135], v[112:127]
    v_exp_f32 v201, v201
    v_exp_f32 v202, v202
    v_exp_f32 v203, v203
    v_exp_f32 v204, v204
    v_exp_f32 v205, v205
    v_exp_f32 v206, v206
    v_exp_f32 v207, v207
    v_cvt_pk_bf16_f32 v136, v192, v193
    v_cvt_pk_bf16_f32 v137, v194, v195
    v_cvt_pk_bf16_f32 v138, v196, v197
    v_cvt_pk_bf16_f32 v139, v198, v199
    v_cvt_pk_bf16_f32 v140, v200, v201
    v_cvt_pk_bf16_f32 v141, v202, v203
    v_cvt_pk_bf16_f32 v142, v204, v205
    v_cvt_pk_bf16_f32 v143, v206, v207
    v_mfma_f32_32x32x16_bf16 v[192:207], v[152:155], v[24:27], 0
    v_exp_f32 v176, v176
    v_exp_f32 v177, v177
    v_exp_f32 v178, v178
    v_mfma_f32_32x32x16_bf16 v[160:175], v[232:235], v[136:139], v[160:175]
    v_exp_f32 v179, v179
    v_exp_f32 v180, v180
    v_exp_f32 v181, v181
    v_mfma_f32_32x32x16_bf16 v[192:207], v[156:159], v[28:31], v[192:207]
    v_exp_f32 v182, v182
    v_exp_f32 v183, v183
    v_exp_f32 v184, v184
    v_mfma_f32_32x32x16_bf16 v[160:175], v[236:239], v[140:143], v[160:175]
    v_exp_f32 v185, v185
    v_exp_f32 v186, v186
    v_exp_f32 v187, v187
    v_exp_f32 v188, v188
    v_exp_f32 v189, v189
    v_exp_f32 v190, v190
    v_exp_f32 v191, v191
    v_cvt_pk_bf16_f32 v128, v176, v177
    v_cvt_pk_bf16_f32 v129, v178, v179
    v_cvt_pk_bf16_f32 v130, v180, v181
    v_cvt_pk_bf16_f32 v131, v182, v183
    v_cvt_pk_bf16_f32 v132, v184, v185
    v_cvt_pk_bf16_f32 v133, v186, v187
    v_cvt_pk_bf16_f32 v134, v188, v189
    v_cvt_pk_bf16_f32 v135, v190, v191
    s_mov_b64 exec, s[92:93]
    buffer_load_dwordx4 v[232:235], v2, s[4:7], s89 offen sc1
    buffer_load_dwordx4 v[236:239], v3, s[4:7], s89 offen sc1
    s_mov_b64 exec, -1
    v_mfma_f32_32x32x16_bf16 v[176:191], v[152:155], v[32:35], 0
    v_exp_f32 v192, v192
    v_exp_f32 v193, v193
    v_exp_f32 v194, v194
    v_mfma_f32_32x32x16_bf16 v[80:95], v[240:243], v[128:131], v[80:95]
    v_exp_f32 v195, v195
    v_exp_f32 v196, v196
    v_exp_f32 v197, v197
    v_mfma_f32_32x32x16_bf16 v[176:191], v[156:159], v[36:39], v[176:191]
    v_exp_f32 v198, v198
    v_exp_f32 v199, v199
    v_exp_f32 v200, v200
    v_mfma_f32_32x32x16_bf16 v[80:95], v[244:247], v[132:135], v[80:95]
    v_exp_f32 v201, v201
    v_exp_f32 v202, v202
    v_exp_f32 v203, v203
    v_exp_f32 v204, v204
    v_exp_f32 v205, v205
    v_exp_f32 v206, v206
    v_exp_f32 v207, v207
    v_cvt_pk_bf16_f32 v136, v192, v193
    v_cvt_pk_bf16_f32 v137, v194, v195
    v_cvt_pk_bf16_f32 v138, v196, v197
    v_cvt_pk_bf16_f32 v139, v198, v199
    v_cvt_pk_bf16_f32 v140, v200, v201
    v_cvt_pk_bf16_f32 v141, v202, v203
    v_cvt_pk_bf16_f32 v142, v204, v205
    v_cvt_pk_bf16_f32 v143, v206, v207
    v_mfma_f32_32x32x16_bf16 v[192:207], v[152:155], v[40:43], 0
    v_exp_f32 v176, v176
    v_exp_f32 v177, v177
    v_exp_f32 v178, v178
    v_mfma_f32_32x32x16_bf16 v[96:111], v[240:243], v[136:139], v[96:111]
    v_exp_f32 v179, v179
    v_exp_f32 v180, v180
    v_exp_f32 v181, v181
    v_mfma_f32_32x32x16_bf16 v[192:207], v[156:159], v[44:47], v[192:207]
    v_exp_f32 v182, v182
    v_exp_f32 v183, v183
    v_exp_f32 v184, v184
    v_mfma_f32_32x32x16_bf16 v[96:111], v[244:247], v[140:143], v[96:111]
    v_exp_f32 v185, v185
    v_exp_f32 v186, v186
    v_exp_f32 v187, v187
    v_exp_f32 v188, v188
    v_exp_f32 v189, v189
    v_exp_f32 v190, v190
    v_exp_f32 v191, v191
    v_cvt_pk_bf16_f32 v128, v176, v177
    v_cvt_pk_bf16_f32 v129, v178, v179
    v_cvt_pk_bf16_f32 v130, v180, v181
    v_cvt_pk_bf16_f32 v131, v182, v183
    v_cvt_pk_bf16_f32 v132, v184, v185
    v_cvt_pk_bf16_f32 v133, v186, v187
    v_cvt_pk_bf16_f32 v134, v188, v189
    v_cvt_pk_bf16_f32 v135, v190, v191
    buffer_load_dwordx4 v[152:155], v8, s[4:7], s90 offen offset:0 sc1
    buffer_load_dwordx4 v[156:159], v8, s[4:7], s90 offen offset:1024 sc1
    s_waitcnt vmcnt(10)
    v_mfma_f32_32x32x16_bf16 v[176:191], v[48:51], v[16:19], 0
    v_exp_f32 v192, v192
    v_exp_f32 v193, v193
    v_exp_f32 v194, v194
    v_mfma_f32_32x32x16_bf16 v[112:127], v[240:243], v[128:131], v[112:127]
    v_exp_f32 v195, v195
    v_exp_f32 v196, v196
    v_exp_f32 v197, v197
    v_mfma_f32_32x32x16_bf16 v[176:191], v[52:55], v[20:23], v[176:191]
    v_exp_f32 v198, v198
    v_exp_f32 v199, v199
    v_exp_f32 v200, v200
    v_mfma_f32_32x32x16_bf16 v[112:127], v[244:247], v[132:135], v[112:127]
    v_exp_f32 v201, v201
    v_exp_f32 v202, v202
    v_exp_f32 v203, v203
    v_exp_f32 v204, v204
    v_exp_f32 v205, v205
    v_exp_f32 v206, v206
    v_exp_f32 v207, v207
    v_cvt_pk_bf16_f32 v136, v192, v193
    v_cvt_pk_bf16_f32 v137, v194, v195
    v_cvt_pk_bf16_f32 v138, v196, v197
    v_cvt_pk_bf16_f32 v139, v198, v199
    v_cvt_pk_bf16_f32 v140, v200, v201
    v_cvt_pk_bf16_f32 v141, v202, v203
    v_cvt_pk_bf16_f32 v142, v204, v205
    v_cvt_pk_bf16_f32 v143, v206, v207
    v_mfma_f32_32x32x16_bf16 v[192:207], v[48:51], v[24:27], 0
    v_exp_f32 v176, v176
    v_exp_f32 v177, v177
    v_exp_f32 v178, v178
    v_mfma_f32_32x32x16_bf16 v[160:175], v[240:243], v[136:139], v[160:175]
    v_exp_f32 v179, v179
    v_exp_f32 v180, v180
    v_exp_f32 v181, v181
    v_mfma_f32_32x32x16_bf16 v[192:207], v[52:55], v[28:31], v[192:207]
    v_exp_f32 v182, v182
    v_exp_f32 v183, v183
    v_exp_f32 v184, v184
    v_mfma_f32_32x32x16_bf16 v[160:175], v[244:247], v[140:143], v[160:175]
    v_exp_f32 v185, v185
    v_exp_f32 v186, v186
    v_exp_f32 v187, v187
    v_exp_f32 v188, v188
    v_exp_f32 v189, v189
    v_exp_f32 v190, v190
    v_exp_f32 v191, v191
    v_cvt_pk_bf16_f32 v128, v176, v177
    v_cvt_pk_bf16_f32 v129, v178, v179
    v_cvt_pk_bf16_f32 v130, v180, v181
    v_cvt_pk_bf16_f32 v131, v182, v183
    v_cvt_pk_bf16_f32 v132, v184, v185
    v_cvt_pk_bf16_f32 v133, v186, v187
    v_cvt_pk_bf16_f32 v134, v188, v189
    v_cvt_pk_bf16_f32 v135, v190, v191
    s_mov_b64 exec, s[92:93]
    buffer_load_dwordx4 v[240:243], v2, s[4:7], s90 offen sc1
    buffer_load_dwordx4 v[244:247], v3, s[4:7], s90 offen sc1
    s_mov_b64 exec, -1
    v_mfma_f32_32x32x16_bf16 v[176:191], v[48:51], v[32:35], 0
    v_exp_f32 v192, v192
    v_exp_f32 v193, v193
    v_exp_f32 v194, v194
    v_mfma_f32_32x32x16_bf16 v[80:95], v[64:67], v[128:131], v[80:95]
    v_exp_f32 v195, v195
    v_exp_f32 v196, v196
    v_exp_f32 v197, v197
    v_mfma_f32_32x32x16_bf16 v[176:191], v[52:55], v[36:39], v[176:191]
    v_exp_f32 v198, v198
    v_exp_f32 v199, v199
    v_exp_f32 v200, v200
    v_mfma_f32_32x32x16_bf16 v[80:95], v[68:71], v[132:135], v[80:95]
    v_exp_f32 v201, v201
    v_exp_f32 v202, v202
    v_exp_f32 v203, v203
    v_exp_f32 v204, v204
    v_exp_f32 v205, v205
    v_exp_f32 v206, v206
    v_exp_f32 v207, v207
    v_cvt_pk_bf16_f32 v136, v192, v193
    v_cvt_pk_bf16_f32 v137, v194, v195
    v_cvt_pk_bf16_f32 v138, v196, v197
    v_cvt_pk_bf16_f32 v139, v198, v199
    v_cvt_pk_bf16_f32 v140, v200, v201
    v_cvt_pk_bf16_f32 v141, v202, v203
    v_cvt_pk_bf16_f32 v142, v204, v205
    v_cvt_pk_bf16_f32 v143, v206, v207
    v_mfma_f32_32x32x16_bf16 v[192:207], v[48:51], v[40:43], 0
    v_exp_f32 v176, v176
    v_exp_f32 v177, v177
    v_exp_f32 v178, v178
    v_mfma_f32_32x32x16_bf16 v[96:111], v[64:67], v[136:139], v[96:111]
    v_exp_f32 v179, v179
    v_exp_f32 v180, v180
    v_exp_f32 v181, v181
    v_mfma_f32_32x32x16_bf16 v[192:207], v[52:55], v[44:47], v[192:207]
    v_exp_f32 v182, v182
    v_exp_f32 v183, v183
    v_exp_f32 v184, v184
    v_mfma_f32_32x32x16_bf16 v[96:111], v[68:71], v[140:143], v[96:111]
    v_exp_f32 v185, v185
    v_exp_f32 v186, v186
    v_exp_f32 v187, v187
    v_exp_f32 v188, v188
    v_exp_f32 v189, v189
    v_exp_f32 v190, v190
    v_exp_f32 v191, v191
    v_cvt_pk_bf16_f32 v128, v176, v177
    v_cvt_pk_bf16_f32 v129, v178, v179
    v_cvt_pk_bf16_f32 v130, v180, v181
    v_cvt_pk_bf16_f32 v131, v182, v183
    v_cvt_pk_bf16_f32 v132, v184, v185
    v_cvt_pk_bf16_f32 v133, v186, v187
    v_cvt_pk_bf16_f32 v134, v188, v189
    v_cvt_pk_bf16_f32 v135, v190, v191
    s_waitcnt vmcnt(8)
    v_mfma_f32_32x32x16_bf16 v[176:191], v[56:59], v[16:19], 0
    v_exp_f32 v192, v192
    v_exp_f32 v193, v193
    v_exp_f32 v194, v194
    v_mfma_f32_32x32x16_bf16 v[112:127], v[64:67], v[128:131], v[112:127]
    v_exp_f32 v195, v195
    v_exp_f32 v196, v196
    v_exp_f32 v197, v197
    v_mfma_f32_32x32x16_bf16 v[176:191], v[60:63], v[20:23], v[176:191]
    v_exp_f32 v198, v198
    v_exp_f32 v199, v199
    v_exp_f32 v200, v200
    v_mfma_f32_32x32x16_bf16 v[112:127], v[68:71], v[132:135], v[112:127]
    v_exp_f32 v201, v201
    v_exp_f32 v202, v202
    v_exp_f32 v203, v203
    v_exp_f32 v204, v204
    v_exp_f32 v205, v205
    v_exp_f32 v206, v206
    v_exp_f32 v207, v207
    v_cvt_pk_bf16_f32 v136, v192, v193
    v_cvt_pk_bf16_f32 v137, v194, v195
    v_cvt_pk_bf16_f32 v138, v196, v197
    v_cvt_pk_bf16_f32 v139, v198, v199
    v_cvt_pk_bf16_f32 v140, v200, v201
    v_cvt_pk_bf16_f32 v141, v202, v203
    v_cvt_pk_bf16_f32 v142, v204, v205
    v_cvt_pk_bf16_f32 v143, v206, v207
    v_mfma_f32_32x32x16_bf16 v[192:207], v[56:59], v[24:27], 0
    v_exp_f32 v176, v176
    v_exp_f32 v177, v177
    v_exp_f32 v178, v178
    v_mfma_f32_32x32x16_bf16 v[160:175], v[64:67], v[136:139], v[160:175]
    v_exp_f32 v179, v179
    v_exp_f32 v180, v180
    v_exp_f32 v181, v181
    v_mfma_f32_32x32x16_bf16 v[192:207], v[60:63], v[28:31], v[192:207]
    v_exp_f32 v182, v182
    v_exp_f32 v183, v183
    v_exp_f32 v184, v184
    v_mfma_f32_32x32x16_bf16 v[160:175], v[68:71], v[140:143], v[160:175]
    v_exp_f32 v185, v185
    v_exp_f32 v186, v186
    v_exp_f32 v187, v187
    v_exp_f32 v188, v188
    v_exp_f32 v189, v189
    v_exp_f32 v190, v190
    v_exp_f32 v191, v191
    v_cvt_pk_bf16_f32 v128, v176, v177
    v_cvt_pk_bf16_f32 v129, v178, v179
    v_cvt_pk_bf16_f32 v130, v180, v181
    v_cvt_pk_bf16_f32 v131, v182, v183
    v_cvt_pk_bf16_f32 v132, v184, v185
    v_cvt_pk_bf16_f32 v133, v186, v187
    v_cvt_pk_bf16_f32 v134, v188, v189
    v_cvt_pk_bf16_f32 v135, v190, v191
    v_mfma_f32_32x32x16_bf16 v[176:191], v[56:59], v[32:35], 0
    v_exp_f32 v192, v192
    v_exp_f32 v193, v193
    v_exp_f32 v194, v194
    v_mfma_f32_32x32x16_bf16 v[80:95], v[72:75], v[128:131], v[80:95]
    v_exp_f32 v195, v195
    v_exp_f32 v196, v196
    v_exp_f32 v197, v197
    v_mfma_f32_32x32x16_bf16 v[176:191], v[60:63], v[36:39], v[176:191]
    v_exp_f32 v198, v198
    v_exp_f32 v199, v199
    v_exp_f32 v200, v200
    v_mfma_f32_32x32x16_bf16 v[80:95], v[76:79], v[132:135], v[80:95]
    v_exp_f32 v201, v201
    v_exp_f32 v202, v202
    v_exp_f32 v203, v203
    v_exp_f32 v204, v204
    v_exp_f32 v205, v205
    v_exp_f32 v206, v206
    v_exp_f32 v207, v207
    v_cvt_pk_bf16_f32 v136, v192, v193
    v_cvt_pk_bf16_f32 v137, v194, v195
    v_cvt_pk_bf16_f32 v138, v196, v197
    v_cvt_pk_bf16_f32 v139, v198, v199
    v_cvt_pk_bf16_f32 v140, v200, v201
    v_cvt_pk_bf16_f32 v141, v202, v203
    v_cvt_pk_bf16_f32 v142, v204, v205
    v_cvt_pk_bf16_f32 v143, v206, v207
    v_mfma_f32_32x32x16_bf16 v[192:207], v[56:59], v[40:43], 0
    v_exp_f32 v176, v176
    v_exp_f32 v177, v177
    v_exp_f32 v178, v178
    v_mfma_f32_32x32x16_bf16 v[96:111], v[72:75], v[136:139], v[96:111]
    v_exp_f32 v179, v179
    v_exp_f32 v180, v180
    v_exp_f32 v181, v181
    v_mfma_f32_32x32x16_bf16 v[192:207], v[60:63], v[44:47], v[192:207]
    v_exp_f32 v182, v182
    v_exp_f32 v183, v183
    v_exp_f32 v184, v184
    v_mfma_f32_32x32x16_bf16 v[96:111], v[76:79], v[140:143], v[96:111]
    v_exp_f32 v185, v185
    v_exp_f32 v186, v186
    v_exp_f32 v187, v187
    v_exp_f32 v188, v188
    v_exp_f32 v189, v189
    v_exp_f32 v190, v190
    v_exp_f32 v191, v191
    v_cvt_pk_bf16_f32 v128, v176, v177
    v_cvt_pk_bf16_f32 v129, v178, v179
    v_cvt_pk_bf16_f32 v130, v180, v181
    v_cvt_pk_bf16_f32 v131, v182, v183
    v_cvt_pk_bf16_f32 v132, v184, v185
    v_cvt_pk_bf16_f32 v133, v186, v187
    v_cvt_pk_bf16_f32 v134, v188, v189
    v_cvt_pk_bf16_f32 v135, v190, v191
    s_waitcnt vmcnt(4)
    v_mfma_f32_32x32x16_bf16 v[176:191], v[144:147], v[16:19], 0
    v_exp_f32 v192, v192
    v_exp_f32 v193, v193
    v_exp_f32 v194, v194
    v_mfma_f32_32x32x16_bf16 v[112:127], v[72:75], v[128:131], v[112:127]
    v_exp_f32 v195, v195
    v_exp_f32 v196, v196
    v_exp_f32 v197, v197
    v_mfma_f32_32x32x16_bf16 v[176:191], v[148:151], v[20:23], v[176:191]
    v_exp_f32 v198, v198
    v_exp_f32 v199, v199
    v_exp_f32 v200, v200
    v_mfma_f32_32x32x16_bf16 v[112:127], v[76:79], v[132:135], v[112:127]
    v_exp_f32 v201, v201
    v_exp_f32 v202, v202
    v_exp_f32 v203, v203
    v_exp_f32 v204, v204
    v_exp_f32 v205, v205
    v_exp_f32 v206, v206
    v_exp_f32 v207, v207
    v_cvt_pk_bf16_f32 v136, v192, v193
    v_cvt_pk_bf16_f32 v137, v194, v195
    v_cvt_pk_bf16_f32 v138, v196, v197
    v_cvt_pk_bf16_f32 v139, v198, v199
    v_cvt_pk_bf16_f32 v140, v200, v201
    v_cvt_pk_bf16_f32 v141, v202, v203
    v_cvt_pk_bf16_f32 v142, v204, v205
    v_cvt_pk_bf16_f32 v143, v206, v207
    v_mfma_f32_32x32x16_bf16 v[192:207], v[144:147], v[24:27], 0
    v_exp_f32 v176, v176
    v_exp_f32 v177, v177
    v_exp_f32 v178, v178
    v_mfma_f32_32x32x16_bf16 v[160:175], v[72:75], v[136:139], v[160:175]
    v_exp_f32 v179, v179
    v_exp_f32 v180, v180
    v_exp_f32 v181, v181
    v_mfma_f32_32x32x16_bf16 v[192:207], v[148:151], v[28:31], v[192:207]
    v_exp_f32 v182, v182
    v_exp_f32 v183, v183
    v_exp_f32 v184, v184
    v_mfma_f32_32x32x16_bf16 v[160:175], v[76:79], v[140:143], v[160:175]
    v_exp_f32 v185, v185
    v_exp_f32 v186, v186
    v_exp_f32 v187, v187
    v_exp_f32 v188, v188
    v_exp_f32 v189, v189
    v_exp_f32 v190, v190
    v_exp_f32 v191, v191
    v_cvt_pk_bf16_f32 v128, v176, v177
    v_cvt_pk_bf16_f32 v129, v178, v179
    v_cvt_pk_bf16_f32 v130, v180, v181
    v_cvt_pk_bf16_f32 v131, v182, v183
    v_cvt_pk_bf16_f32 v132, v184, v185
    v_cvt_pk_bf16_f32 v133, v186, v187
    v_cvt_pk_bf16_f32 v134, v188, v189
    v_cvt_pk_bf16_f32 v135, v190, v191
    v_mfma_f32_32x32x16_bf16 v[176:191], v[144:147], v[32:35], 0
    v_exp_f32 v192, v192
    v_exp_f32 v193, v193
    v_exp_f32 v194, v194
    v_mfma_f32_32x32x16_bf16 v[80:95], v[232:235], v[128:131], v[80:95]
    v_exp_f32 v195, v195
    v_exp_f32 v196, v196
    v_exp_f32 v197, v197
    v_mfma_f32_32x32x16_bf16 v[176:191], v[148:151], v[36:39], v[176:191]
    v_exp_f32 v198, v198
    v_exp_f32 v199, v199
    v_exp_f32 v200, v200
    v_mfma_f32_32x32x16_bf16 v[80:95], v[236:239], v[132:135], v[80:95]
    v_exp_f32 v201, v201
    v_exp_f32 v202, v202
    v_exp_f32 v203, v203
    v_exp_f32 v204, v204
    v_exp_f32 v205, v205
    v_exp_f32 v206, v206
    v_exp_f32 v207, v207
    v_cvt_pk_bf16_f32 v136, v192, v193
    v_cvt_pk_bf16_f32 v137, v194, v195
    v_cvt_pk_bf16_f32 v138, v196, v197
    v_cvt_pk_bf16_f32 v139, v198, v199
    v_cvt_pk_bf16_f32 v140, v200, v201
    v_cvt_pk_bf16_f32 v141, v202, v203
    v_cvt_pk_bf16_f32 v142, v204, v205
    v_cvt_pk_bf16_f32 v143, v206, v207
    v_mfma_f32_32x32x16_bf16 v[192:207], v[144:147], v[40:43], 0
    v_exp_f32 v176, v176
    v_exp_f32 v177, v177
    v_exp_f32 v178, v178
    v_mfma_f32_32x32x16_bf16 v[96:111], v[232:235], v[136:139], v[96:111]
    v_exp_f32 v179, v179
    v_exp_f32 v180, v180
    v_exp_f32 v181, v181
    v_mfma_f32_32x32x16_bf16 v[192:207], v[148:151], v[44:47], v[192:207]
    v_exp_f32 v182, v182
    v_exp_f32 v183, v183
    v_exp_f32 v184, v184
    v_mfma_f32_32x32x16_bf16 v[96:111], v[236:239], v[140:143], v[96:111]
    v_exp_f32 v185, v185
    v_exp_f32 v186, v186
    v_exp_f32 v187, v187
    v_exp_f32 v188, v188
    v_exp_f32 v189, v189
    v_exp_f32 v190, v190
    v_exp_f32 v191, v191
    v_cvt_pk_bf16_f32 v128, v176, v177
    v_cvt_pk_bf16_f32 v129, v178, v179
    v_cvt_pk_bf16_f32 v130, v180, v181
    v_cvt_pk_bf16_f32 v131, v182, v183
    v_cvt_pk_bf16_f32 v132, v184, v185
    v_cvt_pk_bf16_f32 v133, v186, v187
    v_cvt_pk_bf16_f32 v134, v188, v189
    v_cvt_pk_bf16_f32 v135, v190, v191
    s_waitcnt vmcnt(0)
    v_mfma_f32_32x32x16_bf16 v[176:191], v[152:155], v[16:19], 0
    v_exp_f32 v192, v192
    v_exp_f32 v193, v193
    v_exp_f32 v194, v194
    v_mfma_f32_32x32x16_bf16 v[112:127], v[232:235], v[128:131], v[112:127]
    v_exp_f32 v195, v195
    v_exp_f32 v196, v196
    v_exp_f32 v197, v197
    v_mfma_f32_32x32x16_bf16 v[176:191], v[156:159], v[20:23], v[176:191]
    v_exp_f32 v198, v198
    v_exp_f32 v199, v199
    v_exp_f32 v200, v200
    v_mfma_f32_32x32x16_bf16 v[112:127], v[236:239], v[132:135], v[112:127]
    v_exp_f32 v201, v201
    v_exp_f32 v202, v202
    v_exp_f32 v203, v203
    v_exp_f32 v204, v204
    v_exp_f32 v205, v205
    v_exp_f32 v206, v206
    v_exp_f32 v207, v207
    v_cvt_pk_bf16_f32 v136, v192, v193
    v_cvt_pk_bf16_f32 v137, v194, v195
    v_cvt_pk_bf16_f32 v138, v196, v197
    v_cvt_pk_bf16_f32 v139, v198, v199
    v_cvt_pk_bf16_f32 v140, v200, v201
    v_cvt_pk_bf16_f32 v141, v202, v203
    v_cvt_pk_bf16_f32 v142, v204, v205
    v_cvt_pk_bf16_f32 v143, v206, v207
    v_mfma_f32_32x32x16_bf16 v[192:207], v[152:155], v[24:27], 0
    v_exp_f32 v176, v176
    v_exp_f32 v177, v177
    v_exp_f32 v178, v178
    v_mfma_f32_32x32x16_bf16 v[160:175], v[232:235], v[136:139], v[160:175]
    v_exp_f32 v179, v179
    v_exp_f32 v180, v180
    v_exp_f32 v181, v181
    v_mfma_f32_32x32x16_bf16 v[192:207], v[156:159], v[28:31], v[192:207]
    v_exp_f32 v182, v182
    v_exp_f32 v183, v183
    v_exp_f32 v184, v184
    v_mfma_f32_32x32x16_bf16 v[160:175], v[236:239], v[140:143], v[160:175]
    v_exp_f32 v185, v185
    v_exp_f32 v186, v186
    v_exp_f32 v187, v187
    v_exp_f32 v188, v188
    v_exp_f32 v189, v189
    v_exp_f32 v190, v190
    v_exp_f32 v191, v191
    v_cvt_pk_bf16_f32 v128, v176, v177
    v_cvt_pk_bf16_f32 v129, v178, v179
    v_cvt_pk_bf16_f32 v130, v180, v181
    v_cvt_pk_bf16_f32 v131, v182, v183
    v_cvt_pk_bf16_f32 v132, v184, v185
    v_cvt_pk_bf16_f32 v133, v186, v187
    v_cvt_pk_bf16_f32 v134, v188, v189
    v_cvt_pk_bf16_f32 v135, v190, v191
    v_mfma_f32_32x32x16_bf16 v[176:191], v[152:155], v[32:35], 0
    v_exp_f32 v192, v192
    v_exp_f32 v193, v193
    v_exp_f32 v194, v194
    v_mfma_f32_32x32x16_bf16 v[80:95], v[240:243], v[128:131], v[80:95]
    v_exp_f32 v195, v195
    v_exp_f32 v196, v196
    v_exp_f32 v197, v197
    v_mfma_f32_32x32x16_bf16 v[176:191], v[156:159], v[36:39], v[176:191]
    v_exp_f32 v198, v198
    v_exp_f32 v199, v199
    v_exp_f32 v200, v200
    v_mfma_f32_32x32x16_bf16 v[80:95], v[244:247], v[132:135], v[80:95]
    v_exp_f32 v201, v201
    v_exp_f32 v202, v202
    v_exp_f32 v203, v203
    v_exp_f32 v204, v204
    v_exp_f32 v205, v205
    v_exp_f32 v206, v206
    v_exp_f32 v207, v207
    v_cvt_pk_bf16_f32 v136, v192, v193
    v_cvt_pk_bf16_f32 v137, v194, v195
    v_cvt_pk_bf16_f32 v138, v196, v197
    v_cvt_pk_bf16_f32 v139, v198, v199
    v_cvt_pk_bf16_f32 v140, v200, v201
    v_cvt_pk_bf16_f32 v141, v202, v203
    v_cvt_pk_bf16_f32 v142, v204, v205
    v_cvt_pk_bf16_f32 v143, v206, v207
    v_mfma_f32_32x32x16_bf16 v[192:207], v[152:155], v[40:43], 0
    v_exp_f32 v176, v176
    v_exp_f32 v177, v177
    v_exp_f32 v178, v178
    v_mfma_f32_32x32x16_bf16 v[96:111], v[240:243], v[136:139], v[96:111]
    v_exp_f32 v179, v179
    v_exp_f32 v180, v180
    v_exp_f32 v181, v181
    v_mfma_f32_32x32x16_bf16 v[192:207], v[156:159], v[44:47], v[192:207]
    v_exp_f32 v182, v182
    v_exp_f32 v183, v183
    v_exp_f32 v184, v184
    v_mfma_f32_32x32x16_bf16 v[96:111], v[244:247], v[140:143], v[96:111]
    v_exp_f32 v185, v185
    v_exp_f32 v186, v186
    v_exp_f32 v187, v187
    v_exp_f32 v188, v188
    v_exp_f32 v189, v189
    v_exp_f32 v190, v190
    v_exp_f32 v191, v191
    v_cvt_pk_bf16_f32 v128, v176, v177
    v_cvt_pk_bf16_f32 v129, v178, v179
    v_cvt_pk_bf16_f32 v130, v180, v181
    v_cvt_pk_bf16_f32 v131, v182, v183
    v_cvt_pk_bf16_f32 v132, v184, v185
    v_cvt_pk_bf16_f32 v133, v186, v187
    v_cvt_pk_bf16_f32 v134, v188, v189
    v_cvt_pk_bf16_f32 v135, v190, v191
    v_exp_f32 v192, v192
    v_exp_f32 v193, v193
    v_exp_f32 v194, v194
    v_mfma_f32_32x32x16_bf16 v[112:127], v[240:243], v[128:131], v[112:127]
    v_exp_f32 v195, v195
    v_exp_f32 v196, v196
    v_exp_f32 v197, v197
    v_exp_f32 v198, v198
    v_exp_f32 v199, v199
    v_exp_f32 v200, v200
    v_mfma_f32_32x32x16_bf16 v[112:127], v[244:247], v[132:135], v[112:127]
    v_exp_f32 v201, v201
    v_exp_f32 v202, v202
    v_exp_f32 v203, v203
    v_exp_f32 v204, v204
    v_exp_f32 v205, v205
    v_exp_f32 v206, v206
    v_exp_f32 v207, v207
    v_cvt_pk_bf16_f32 v136, v192, v193
    v_cvt_pk_bf16_f32 v137, v194, v195
    v_cvt_pk_bf16_f32 v138, v196, v197
    v_cvt_pk_bf16_f32 v139, v198, v199
    v_cvt_pk_bf16_f32 v140, v200, v201
    v_cvt_pk_bf16_f32 v141, v202, v203
    v_cvt_pk_bf16_f32 v142, v204, v205
    v_cvt_pk_bf16_f32 v143, v206, v207
    s_nop 1
    v_mfma_f32_32x32x16_bf16 v[160:175], v[240:243], v[136:139], v[160:175]
    v_mfma_f32_32x32x16_bf16 v[160:175], v[244:247], v[140:143], v[160:175]
    s_nop 3
    ds_write_b128 v4, v[96:99] offset:0
    ds_write_b128 v4, v[100:103] offset:1024
    ds_write_b128 v4, v[104:107] offset:2048
    ds_write_b128 v4, v[108:111] offset:3072
    ds_write_b128 v5, v[112:115] offset:0
    ds_write_b128 v5, v[116:119] offset:1024
    ds_write_b128 v5, v[120:123] offset:2048
    ds_write_b128 v5, v[124:127] offset:3072
    ds_write_b128 v6, v[160:163] offset:0
    ds_write_b128 v6, v[164:167] offset:1024
    ds_write_b128 v6, v[168:171] offset:2048
    ds_write_b128 v6, v[172:175] offset:3072
    s_waitcnt lgkmcnt(0)
    s_mov_b64 exec, 1
    ds_add_u32 v12, v13
    s_mov_b64 exec, -1
    s_mov_b32 s91, 1600000
L_parallel_sum__softmax_full_mha__glu_gated_swiglu__prompt_kernel_ra:
    ds_read_b32 v209, v12
    s_waitcnt lgkmcnt(0)
    v_cmp_ne_u32 vcc, 4, v209
    s_cbranch_vccz L_parallel_sum__softmax_full_mha__glu_gated_swiglu__prompt_kernel_ra_ok
    s_sub_u32 s91, s91, 1
    s_cbranch_scc0 L_parallel_sum__softmax_full_mha__glu_gated_swiglu__prompt_kernel_ra
L_parallel_sum__softmax_full_mha__glu_gated_swiglu__prompt_kernel_ra_ok:
    ds_read_b128 v[96:99], v7 offset:0
    ds_read_b128 v[100:103], v7 offset:1024
    ds_read_b128 v[104:107], v7 offset:2048
    ds_read_b128 v[108:111], v7 offset:3072
    ds_read_b128 v[112:115], v7 offset:4096
    ds_read_b128 v[116:119], v7 offset:5120
    ds_read_b128 v[120:123], v7 offset:6144
    ds_read_b128 v[124:127], v7 offset:7168
    ds_read_b128 v[160:163], v7 offset:8192
    ds_read_b128 v[164:167], v7 offset:9216
    ds_read_b128 v[168:171], v7 offset:10240
    ds_read_b128 v[172:175], v7 offset:11264
    s_waitcnt lgkmcnt(8)
    v_add_f32 v176, v80, v96
    v_add_f32 v177, v81, v97
    v_add_f32 v178, v82, v98
    v_add_f32 v179, v83, v99
    v_add_f32 v180, v84, v100
    v_add_f32 v181, v85, v101
    v_add_f32 v182, v86, v102
    v_add_f32 v183, v87, v103
    v_add_f32 v184, v88, v104
    v_add_f32 v185, v89, v105
    v_add_f32 v186, v90, v106
    v_add_f32 v187, v91, v107
    v_add_f32 v188, v92, v108
    v_add_f32 v189, v93, v109
    v_add_f32 v190, v94, v110
    v_add_f32 v191, v95, v111
    s_waitcnt lgkmcnt(4)
    v_add_f32 v176, v176, v112
    v_add_f32 v177, v177, v113
    v_add_f32 v178, v178, v114
    v_add_f32 v179, v179, v115
    v_add_f32 v180, v180, v116
    v_add_f32 v181, v181, v117
    v_add_f32 v182, v182, v118
    v_add_f32 v183, v183, v119
    v_add_f32 v184, v184, v120
    v_add_f32 v185, v185, v121
    v_add_f32 v186, v186, v122
    v_add_f32 v187, v187, v123
    v_add_f32 v188, v188, v124
    v_add_f32 v189, v189, v125
    v_add_f32 v190, v190, v126
    v_add_f32 v191, v191, v127
    s_waitcnt lgkmcnt(0)
    s_mov_b64 exec, 1
    ds_add_u32 v14, v13
    s_mov_b64 exec, -1
    v_add_f32 v176, v176, v160
    v_add_f32 v177, v177, v161
    v_add_f32 v178, v178, v162
    v_add_f32 v179, v179, v163
    v_add_f32 v180, v180, v164
    v_add_f32 v181, v181, v165
    v_add_f32 v182, v182, v166
    v_add_f32 v183, v183, v167
    v_add_f32 v184, v184, v168
    v_add_f32 v185, v185, v169
    v_add_f32 v186, v186, v170
    v_add_f32 v187, v187, v171
    v_add_f32 v188, v188, v172
    v_add_f32 v189, v189, v173
    v_add_f32 v190, v190, v174
    v_add_f32 v191, v191, v175
L_parallel_sum__softmax_full_mha__glu_gated_swiglu__prompt_kernel_norm:
    v_mov_b32 v208, v188
    v_mov_b32 v209, v188
    v_maximum3_f32 v210, |v176|, |v177|, |v178|
    v_maximum3_f32 v211, |v179|, |v180|, |v181|
    v_permlane32_swap_b32 v208, v209
    v_maximum3_f32 v210, |v182|, |v183|, v210
    v_maximum3_f32 v211, |v184|, |v185|, v211
    v_maximum3_f32 v210, |v186|, |v187|, v210
    v_maximum3_f32 v211, |v188|, |v189|, v211
    v_maximum3_f32 v210, |v190|, |v191|, v210
    v_maximum3_f32 v210, v210, v211, v211
    v_cmp_nge_f32 vcc, v209, s84
    v_cmp_nle_f32 s[94:95], v209, s85
    v_cmp_nle_f32 s[96:97], v210, s86
    v_rcp_f32 v209, v209
    s_nop 0
    s_or_b64 s[94:95], s[94:95], vcc
    s_or_b64 s[94:95], s[94:95], s[96:97]
    s_cmp_eq_u32 s63, 2
    s_cselect_b64 s[94:95], 0, s[94:95]
    s_cmp_lg_u64 s[94:95], 0
    s_cbranch_scc1 L_parallel_sum__softmax_full_mha__glu_gated_swiglu__prompt_kernel_slow
    v_mul_f32 v176, v209, v176
    v_mul_f32 v177, v209, v177
    v_mul_f32 v178, v209, v178
    v_mul_f32 v179, v209, v179
    v_mul_f32 v180, v209, v180
    v_mul_f32 v181, v209, v181
    v_mul_f32 v182, v209, v182
    v_mul_f32 v183, v209, v183
    v_mul_f32 v184, v209, v184
    v_mul_f32 v185, v209, v185
    v_mul_f32 v186, v209, v186
    v_mul_f32 v187, v209, v187
    v_mul_f32 v188, v209, v188
    v_mul_f32 v189, v209, v189
    v_mul_f32 v190, v209, v190
    v_mul_f32 v191, v209, v191
    v_cvt_pk_bf16_f32 v212, v176, v177
    v_cvt_pk_bf16_f32 v213, v178, v179
    v_cvt_pk_bf16_f32 v214, v180, v181
    v_cvt_pk_bf16_f32 v215, v182, v183
    v_cvt_pk_bf16_f32 v216, v184, v185
    v_cvt_pk_bf16_f32 v217, v186, v187
    v_cvt_pk_bf16_f32 v218, v188, v189
    v_cvt_pk_bf16_f32 v219, v190, v191
    s_mov_b32 exec_lo, 0
    v_mov_b32 v218, 0
    v_mov_b32 v219, 0
    s_mov_b64 exec, -1
    buffer_store_dwordx4 v[212:215], v1, s[4:7], s64 offen sc1
    buffer_store_dwordx4 v[216:219], v1, s[4:7], s64 offen offset:1024 sc1
    v_mov_b32 v209, 0
    s_waitcnt vmcnt(0)
    s_mov_b64 exec, 1
    buffer_store_dword v13, v209, s[4:7], s83 offen sc1
    s_mov_b64 exec, -1
    s_branch L_parallel_sum__softmax_full_mha__glu_gated_swiglu__prompt_kernel_adone
L_parallel_sum__softmax_full_mha__glu_gated_swiglu__prompt_kernel_slow:
    s_mov_b32 s63, 2
    v_mov_b32 v210, 0xff800000
    s_mov_b32 s36, 0
L_parallel_sum__softmax_full_mha__glu_gated_swiglu__prompt_kernel_sl1:
    buffer_load_dwordx4 v[48:51], v8, s[4:7], s36 offen offset:0 sc1
    buffer_load_dwordx4 v[52:55], v8, s[4:7], s36 offen offset:1024 sc1
    s_waitcnt vmcnt(0)
    v_mfma_f32_32x32x16_bf16 v[192:207], v[48:51], v[16:19], 0
    v_mfma_f32_32x32x16_bf16 v[192:207], v[52:55], v[20:23], v[192:207]
    s_nop 7
    s_nop 4
    v_max3_f32 v210, v192, v193, v210
    v_max3_f32 v210, v194, v195, v210
    v_max3_f32 v210, v196, v197, v210
    v_max3_f32 v210, v198, v199, v210
    v_max3_f32 v210, v200, v201, v210
    v_max3_f32 v210, v202, v203, v210
    v_max3_f32 v210, v204, v205, v210
    v_max3_f32 v210, v206, v207, v210
    s_add_u32 s36, s36, 28672
    s_cmp_lt_u32 s36, 1835008
    s_cbranch_scc1 L_parallel_sum__softmax_full_mha__glu_gated_swiglu__prompt_kernel_sl1
    v_mov_b32 v211, v210
    s_nop 1
    v_permlane32_swap_b32 v210, v211
    s_nop 1
    v_max_f32 v210, v210, v211
    s_mov_b32 s36, 0
    v_mov_b32 v96, 0
    v_mov_b32 v97, 0
    v_mov_b32 v98, 0
    v_mov_b32 v99, 0
    v_mov_b32 v100, 0
    v_mov_b32 v101, 0
    v_mov_b32 v102, 0
    v_mov_b32 v103, 0
    v_mov_b32 v104, 0
    v_mov_b32 v105, 0
    v_mov_b32 v106, 0
    v_mov_b32 v107, 0
    v_mov_b32 v108, 0
    v_mov_b32 v109, 0
    v_mov_b32 v110, 0
    v_mov_b32 v111, 0
L_parallel_sum__softmax_full_mha__glu_gated_swiglu__prompt_kernel_sl2:
    buffer_load_dwordx4 v[48:51], v8, s[4:7], s36 offen offset:0 sc1
    buffer_load_dwordx4 v[52:55], v8, s[4:7], s36 offen offset:1024 sc1
    s_mov_b64 exec, s[92:93]
    buffer_load_dwordx4 v[64:67], v2, s[4:7], s36 offen sc1
    buffer_load_dwordx4 v[68:71], v3, s[4:7], s36 offen sc1
    s_mov_b64 exec, -1
    s_waitcnt vmcnt(0)
    v_mfma_f32_32x32x16_bf16 v[192:207], v[48:51], v[16:19], 0
    v_mfma_f32_32x32x16_bf16 v[192:207], v[52:55], v[20:23], v[192:207]
    s_nop 7
    s_nop 4
    v_sub_f32 v192, v192, v210
    v_sub_f32 v193, v193, v210
    v_sub_f32 v194, v194, v210
    v_sub_f32 v195, v195, v210
    v_sub_f32 v196, v196, v210
    v_sub_f32 v197, v197, v210
    v_sub_f32 v198, v198, v210
    v_sub_f32 v199, v199, v210
    v_sub_f32 v200, v200, v210
    v_sub_f32 v201, v201, v210
    v_sub_f32 v202, v202, v210
    v_sub_f32 v203, v203, v210
    v_sub_f32 v204, v204, v210
    v_sub_f32 v205, v205, v210
    v_sub_f32 v206, v206, v210
    v_sub_f32 v207, v207, v210
    v_exp_f32 v192, v192
    v_exp_f32 v193, v193
    v_exp_f32 v194, v194
    v_exp_f32 v195, v195
    v_exp_f32 v196, v196
    v_exp_f32 v197, v197
    v_exp_f32 v198, v198
    v_exp_f32 v199, v199
    v_exp_f32 v200, v200
    v_exp_f32 v201, v201
    v_exp_f32 v202, v202
    v_exp_f32 v203, v203
    v_exp_f32 v204, v204
    v_exp_f32 v205, v205
    v_exp_f32 v206, v206
    v_exp_f32 v207, v207
    s_nop 0
    v_cvt_pk_bf16_f32 v128, v192, v193
    v_cvt_pk_bf16_f32 v129, v194, v195
    v_cvt_pk_bf16_f32 v130, v196, v197
    v_cvt_pk_bf16_f32 v131, v198, v199
    v_cvt_pk_bf16_f32 v132, v200, v201
    v_cvt_pk_bf16_f32 v133, v202, v203
    v_cvt_pk_bf16_f32 v134, v204, v205
    v_cvt_pk_bf16_f32 v135, v206, v207
    s_nop 1
    v_mfma_f32_32x32x16_bf16 v[96:111], v[64:67], v[128:131], v[96:111]
    v_mfma_f32_32x32x16_bf16 v[96:111], v[68:71], v[132:135], v[96:111]
    s_add_u32 s36, s36, 28672
    s_cmp_lt_u32 s36, 1835008
    s_cbranch_scc1 L_parallel_sum__softmax_full_mha__glu_gated_swiglu__prompt_kernel_sl2
    s_nop 7
    s_nop 4
    v_mov_b32 v176, v96
    v_mov_b32 v177, v97
    v_mov_b32 v178, v98
    v_mov_b32 v179, v99
    v_mov_b32 v180, v100
    v_mov_b32 v181, v101
    v_mov_b32 v182, v102
    v_mov_b32 v183, v103
    v_mov_b32 v184, v104
    v_mov_b32 v185, v105
    v_mov_b32 v186, v106
    v_mov_b32 v187, v107
    v_mov_b32 v188, v108
    v_mov_b32 v189, v109
    v_mov_b32 v190, v110
    v_mov_b32 v191, v111
    s_branch L_parallel_sum__softmax_full_mha__glu_gated_swiglu__prompt_kernel_norm
L_parallel_sum__softmax_full_mha__glu_gated_swiglu__prompt_kernel_adone:
L_parallel_sum__softmax_full_mha__glu_gated_swiglu__prompt_kernel_exit:
L_parallel_sum__softmax_full_mha__glu_gated_swiglu__prompt_kernel_end:
L_parallel_sum__softmax_full_mha__glu_gated_swiglu__prompt_kernel_last:
    s_endpgm
.section .rodata,"a"
.p2align 6
.amdhsa_kernel parallel_sum__softmax_full_mha__glu_gated_swiglu__prompt_kernel
  .amdhsa_next_free_vgpr 256
  .amdhsa_next_free_sgpr 102
  .amdhsa_accum_offset 256
  .amdhsa_group_segment_fixed_size 0
  .amdhsa_kernarg_size 80
  .amdhsa_user_sgpr_count 2
  .amdhsa_user_sgpr_kernarg_segment_ptr 1
  .amdhsa_system_sgpr_workgroup_id_x 1
.end_amdhsa_kernel
```
